```python
import torch

def _softmax(x, axis=-1):
    return torch.softmax(x, dim=axis)

def _gelu(x):
    return torch.nn.functional.gelu(x, approximate='tanh')

def _silu(x):
    return torch.nn.functional.silu(x)

def _sigmoid(x):
    return torch.sigmoid(x)

def _layernorm(x, axis=-1, eps=1e-05):
    m = x.mean(dim=axis, keepdim=True)
    v = x.var(dim=axis, keepdim=True, unbiased=False)
    return (x - m) / torch.sqrt(v + eps)

def _scatter_add(tgt, idx, src, axis=0):
    return tgt.clone().index_add_(axis, idx, src)

def _segment_sum(src, seg, n):
    out = torch.zeros((n,) + src.shape[1:], dtype=src.dtype)
    return out.index_add_(0, seg, src)

def _pad(x, pw):
    flat = tuple((v for pair in reversed(pw) for v in pair))
    return torch.nn.functional.pad(x, flat)
kernel_name = 'standalone__autoregressive_conv_wavenet__speech'

def setup_inputs():

    _w = lambda a: (lambda t: t.to(torch.bfloat16) if t.is_floating_point() else t)(torch.as_tensor(a))
    B, T, D, K = (2, 1000, 512, 31)
    return {'x': _w((lambda *s: torch.randn(*s, dtype=torch.bfloat16) * 0.05)(B, T, D)), 'w': _w((lambda *s: torch.randn(*s, dtype=torch.bfloat16) * 0.05)(K, D, 2 * D)), 'w_o': _w((lambda *s: torch.randn(*s, dtype=torch.bfloat16) * 0.05)(D, D))}

def reference(x, w, w_o):
    B, T, D = x.shape
    K = w.shape[0]
    dil = 2
    pad = (K - 1) * dil
    xp = _pad(x, ((0, 0), (pad, 0), (0, 0)))
    h = torch.einsum('btc,cd->btd', xp[:, pad:pad + T, :], w[0])
    for i in range(1, K):
        off = pad - i * dil
        h = h + torch.einsum('btc,cd->btd', xp[:, off:off + T, :], w[i])
    f = h[..., :D].clone()
    g = h[..., D:].clone()
    z = torch.tanh(f) * _sigmoid(g)
    return z @ w_o
```

```asm
; @launch grid=(256,1,1) block=(256,1,1) lds=159744
.amdgcn_target "amdgcn-amd-amdhsa--gfx950"
.text
.globl standalone__autoregressive_conv_wavenet__speech_kernel
.p2align 8
.type standalone__autoregressive_conv_wavenet__speech_kernel,@function
standalone__autoregressive_conv_wavenet__speech_kernel:
    s_cmp_ge_u32 s2, 256
    s_cbranch_scc1 L_end
    s_load_dwordx2 s[16:17], s[0:1], 0
    s_load_dwordx2 s[20:21], s[0:1], 8
    s_load_dwordx2 s[24:25], s[0:1], 40
    s_load_dwordx2 s[28:29], s[0:1], 16
    s_load_dwordx2 s[32:33], s[0:1], 24
    s_lshr_b32 s15, s2, 3
    v_lshl_add_u32 v25, v0, 5, s15
    s_getpc_b64 s[12:13]
    v_min_u32 v25, (L_end-standalone__autoregressive_conv_wavenet__speech_kernel)/128, v25
    v_lshlrev_b32 v25, 7, v25
    s_and_b32 s12, s12, 0xffffff00
    v_mov_b32 v251, s13
    v_add_co_u32 v250, vcc, s12, v25
    v_lshrrev_b32 v1, 6, v0
    v_and_b32 v0, 63, v0
    v_addc_co_u32 v251, vcc, 0, v251, vcc
    v_readfirstlane_b32 s3, v1
    global_load_dword v252, v[250:251], off
    s_and_b32 s14, s2, 7
    s_lshr_b32 s39, s15, 1
    s_and_b32 s40, s15, 1
    s_lshl1_add_u32 s40, s14, s40
    s_lshr_b32 s4, s39, 3
    s_mul_i32 s4, s4, 1024000
    s_and_b32 s41, s39, 3
    s_lshl3_add_u32 s41, s41, s3
    s_sub_u32 s41, s41, 2
    s_lshl_b32 s41, s41, 15
    s_bfe_u32 s42, s39, 0x10002
    s_lshl4_add_u32 s42, s42, s40
    s_lshl_b32 s42, s42, 6
    s_add_u32 s41, s41, s42
    v_lshrrev_b32 v2, 2, v0
    v_and_b32 v3, 3, v0
    v_lshlrev_b32 v2, 11, v2
    v_lshl_add_u32 v2, v3, 4, v2
    v_add_u32 v4, s41, v2
    v_add_u32 v5, 0x20000, v4
    v_add_u32 v6, 0x40000, v4
    v_min_u32 v4, 2146435072, v4
    s_lshl_b32 s5, s3, 10
    s_add_u32 s5, s5, 147456
    s_mov_b32 s18, 1024000
    s_mov_b32 s19, 0x00020000
    s_mov_b32 s22, 32505856
    s_mov_b32 s23, 0x00020000
    s_mov_b32 s26, 268435456
    s_mov_b32 s27, 0x00020000
    s_mul_i32 s41, s15, 52
    s_lshr_b32 s41, s41, 8
    s_mul_i32 s48, s41, 5
    s_sub_u32 s48, s15, s48
    s_mul_i32 s42, s14, 6
    s_add_u32 s42, s42, s41
    s_min_u32 s43, s14, 5
    s_lshl3_add_u32 s43, s43, 3
    s_cmp_ge_u32 s15, 30
    s_cselect_b32 s59, 1, 0
    s_cselect_b32 s42, s43, s42
    s_cselect_b32 s41, 0, 1
    s_cselect_b32 s62, 2, 2
    s_lshr_b32 s49, s42, 4
    s_lshl_b32 s49, s49, 1
    s_lshr_b32 s49, 0x18, s49
    s_and_b32 s49, s49, 3
    s_and_b32 s52, s42, 15
    s_mul_i32 s43, s49, 11
    s_lshr_b32 s68, s48, s41
    s_and_b32 s68, s68, 1
    s_waitcnt lgkmcnt(0)
    s_mov_b32 m0, s5
    s_add_u32 s16, s16, s4
    s_addc_u32 s17, s17, 0
    buffer_load_dwordx4 v4, s[16:19], 0 offen nt lds
    s_add_u32 m0, s5, 4096
    s_mov_b32 s4, 42139648
    buffer_load_dwordx4 v5, s[16:19], 0 offen nt lds
    s_add_u32 m0, s5, 8192
    s_cmp_ge_u32 s3, 2
    s_load_dwordx2 s[46:47], s[24:25], s4
    s_cbranch_scc1 L_x2
    buffer_load_dwordx4 v6, s[16:19], 0 offen nt lds
L_x2:
    s_lshl_b32 s41, s2, 7
    s_add_u32 s41, s41, 41943040
    buffer_load_dword v253, off, s[24:27], s41
    s_lshl2_add_u32 s41, s59, s48
    s_and_b32 s42, s48, 1
    s_cmp_lt_u32 s41, 4
    s_cselect_b32 s62, s42, s62
    s_lshl_b32 s54, s43, 15
    s_lshl_b32 s41, s52, 7
    s_add_u32 s54, s54, s41
    s_lshl1_add_u32 s65, s62, s68
    s_lshl_b32 s65, s65, 14
    s_lshl_b32 s56, s3, 13
    s_cmp_eq_u32 s49, 2
    s_cselect_b32 s58, 10, 11
    s_cselect_b32 s50, 1, 2
    s_cselect_b32 s64, 2, 0
    s_cselect_b32 s51, 0, 1
    s_cmp_eq_u32 s68, 1
    s_cselect_b32 s69, s64, s50
    s_cselect_b32 s64, s50, s64
    s_lshl_b32 s69, s69, 15
    s_add_u32 s69, s69, s56
    v_bfe_u32 v21, v0, 3, 1
    v_lshrrev_b32 v22, 4, v0
    v_lshl_add_u32 v21, v21, 2, v22
    v_and_b32 v22, 7, v0
    v_lshlrev_b32 v22, 4, v22
    s_lshl_b32 s41, s3, 23
    s_add_u32 s41, s41, s54
    v_lshl_add_u32 v21, v21, 11, v22
    v_add_u32 v12, s41, v21
    v_xor_b32 v23, 32, v12
    v_add_u32 v13, 1047552, v23
    v_xor_b32 v23, 64, v12
    v_add_u32 v14, 2095104, v23
    v_xor_b32 v23, 96, v12
    v_add_u32 v15, 3142656, v23
    s_add_u32 m0, s69, 0
    s_nop 0
    buffer_load_dwordx4 v12, s[20:23], s65 offen offset:0 lds
    buffer_load_dwordx4 v13, s[20:23], s65 offen offset:1024 lds
    buffer_load_dwordx4 v14, s[20:23], s65 offen offset:2048 lds
    buffer_load_dwordx4 v15, s[20:23], s65 offen offset:3072 lds
    v_add_u32 v16, 0x400000, v12
    v_add_u32 v17, 0x400000, v13
    v_add_u32 v18, 0x400000, v14
    v_add_u32 v19, 0x400000, v15
    v_and_b32 v11, 15, v0
    v_lshl_add_u32 v8, s3, 4, v11
    v_lshl_add_u32 v8, v8, 1, 1
    v_cvt_f32_u32 v8, v8
    v_mul_f32 v8, 0x3b4ccccd, v8
    v_bfe_u32 v6, v0, 4, 1
    v_cvt_f32_u32 v9, v6
    v_mul_f32 v9, 0x3e800000, v9
    v_lshrrev_b32 v4, 5, v0
    v_lshlrev_b32 v10, 3, v4
    v_cvt_f32_u32 v10, v10
    v_add_f32 v10, 0xc2bf0000, v10
    v_fma_f32 v9, v8, v10, v9
    v_fract_f32 v9, v9
    v_mul_f32 v208, 0x41800000, v8
    v_cos_f32 v208, v208
    v_fmamk_f32 v184, v8, 0x00000000, v9
    v_fmamk_f32 v185, v8, 0x3f800000, v9
    v_fmamk_f32 v186, v8, 0x40000000, v9
    v_fmamk_f32 v187, v8, 0x40400000, v9
    v_fmamk_f32 v188, v8, 0x40800000, v9
    v_fmamk_f32 v189, v8, 0x40a00000, v9
    v_fmamk_f32 v190, v8, 0x40c00000, v9
    v_fmamk_f32 v191, v8, 0x40e00000, v9
    v_cos_f32 v184, v184
    v_cos_f32 v185, v185
    v_cos_f32 v186, v186
    v_cos_f32 v187, v187
    v_cos_f32 v188, v188
    v_cos_f32 v189, v189
    v_cos_f32 v190, v190
    v_cos_f32 v191, v191
    v_fmamk_f32 v192, v8, 0x41800000, v9
    v_fmamk_f32 v193, v8, 0x41880000, v9
    v_fmamk_f32 v194, v8, 0x41900000, v9
    v_fmamk_f32 v195, v8, 0x41980000, v9
    v_fmamk_f32 v196, v8, 0x41a00000, v9
    v_fmamk_f32 v197, v8, 0x41a80000, v9
    v_fmamk_f32 v198, v8, 0x41b00000, v9
    v_fmamk_f32 v199, v8, 0x41b80000, v9
    v_cos_f32 v192, v192
    v_cos_f32 v193, v193
    v_cos_f32 v194, v194
    v_cos_f32 v195, v195
    v_cos_f32 v196, v196
    v_cos_f32 v197, v197
    v_cos_f32 v198, v198
    v_cos_f32 v199, v199
    v_add_f32 v208, v208, v208
    v_cvt_pk_bf16_f32 v32, v184, v185
    v_cvt_pk_bf16_f32 v33, v186, v187
    v_cvt_pk_bf16_f32 v34, v188, v189
    v_cvt_pk_bf16_f32 v35, v190, v191
    v_cvt_pk_bf16_f32 v36, v192, v193
    v_cvt_pk_bf16_f32 v37, v194, v195
    v_cvt_pk_bf16_f32 v38, v196, v197
    v_cvt_pk_bf16_f32 v39, v198, v199
    v_pk_fma_f32 v[200:201], v[208:209], v[192:193], v[184:185] op_sel_hi:[0,1,1] neg_lo:[0,0,1] neg_hi:[0,0,1]
    v_pk_fma_f32 v[202:203], v[208:209], v[194:195], v[186:187] op_sel_hi:[0,1,1] neg_lo:[0,0,1] neg_hi:[0,0,1]
    v_pk_fma_f32 v[204:205], v[208:209], v[196:197], v[188:189] op_sel_hi:[0,1,1] neg_lo:[0,0,1] neg_hi:[0,0,1]
    v_pk_fma_f32 v[206:207], v[208:209], v[198:199], v[190:191] op_sel_hi:[0,1,1] neg_lo:[0,0,1] neg_hi:[0,0,1]
    v_cvt_pk_bf16_f32 v40, v200, v201
    v_cvt_pk_bf16_f32 v41, v202, v203
    v_cvt_pk_bf16_f32 v42, v204, v205
    v_cvt_pk_bf16_f32 v43, v206, v207
    v_pk_fma_f32 v[184:185], v[208:209], v[200:201], v[192:193] op_sel_hi:[0,1,1] neg_lo:[0,0,1] neg_hi:[0,0,1]
    v_pk_fma_f32 v[186:187], v[208:209], v[202:203], v[194:195] op_sel_hi:[0,1,1] neg_lo:[0,0,1] neg_hi:[0,0,1]
    v_pk_fma_f32 v[188:189], v[208:209], v[204:205], v[196:197] op_sel_hi:[0,1,1] neg_lo:[0,0,1] neg_hi:[0,0,1]
    v_pk_fma_f32 v[190:191], v[208:209], v[206:207], v[198:199] op_sel_hi:[0,1,1] neg_lo:[0,0,1] neg_hi:[0,0,1]
    v_cvt_pk_bf16_f32 v44, v184, v185
    v_cvt_pk_bf16_f32 v45, v186, v187
    v_cvt_pk_bf16_f32 v46, v188, v189
    v_cvt_pk_bf16_f32 v47, v190, v191
    v_pk_fma_f32 v[192:193], v[208:209], v[184:185], v[200:201] op_sel_hi:[0,1,1] neg_lo:[0,0,1] neg_hi:[0,0,1]
    v_pk_fma_f32 v[194:195], v[208:209], v[186:187], v[202:203] op_sel_hi:[0,1,1] neg_lo:[0,0,1] neg_hi:[0,0,1]
    v_pk_fma_f32 v[196:197], v[208:209], v[188:189], v[204:205] op_sel_hi:[0,1,1] neg_lo:[0,0,1] neg_hi:[0,0,1]
    v_pk_fma_f32 v[198:199], v[208:209], v[190:191], v[206:207] op_sel_hi:[0,1,1] neg_lo:[0,0,1] neg_hi:[0,0,1]
    v_cvt_pk_bf16_f32 v48, v192, v193
    v_cvt_pk_bf16_f32 v49, v194, v195
    v_cvt_pk_bf16_f32 v50, v196, v197
    v_cvt_pk_bf16_f32 v51, v198, v199
    v_pk_fma_f32 v[200:201], v[208:209], v[192:193], v[184:185] op_sel_hi:[0,1,1] neg_lo:[0,0,1] neg_hi:[0,0,1]
    v_pk_fma_f32 v[202:203], v[208:209], v[194:195], v[186:187] op_sel_hi:[0,1,1] neg_lo:[0,0,1] neg_hi:[0,0,1]
    v_pk_fma_f32 v[204:205], v[208:209], v[196:197], v[188:189] op_sel_hi:[0,1,1] neg_lo:[0,0,1] neg_hi:[0,0,1]
    v_pk_fma_f32 v[206:207], v[208:209], v[198:199], v[190:191] op_sel_hi:[0,1,1] neg_lo:[0,0,1] neg_hi:[0,0,1]
    v_cvt_pk_bf16_f32 v52, v200, v201
    v_cvt_pk_bf16_f32 v53, v202, v203
    v_cvt_pk_bf16_f32 v54, v204, v205
    v_cvt_pk_bf16_f32 v55, v206, v207
    v_pk_fma_f32 v[184:185], v[208:209], v[200:201], v[192:193] op_sel_hi:[0,1,1] neg_lo:[0,0,1] neg_hi:[0,0,1]
    v_pk_fma_f32 v[186:187], v[208:209], v[202:203], v[194:195] op_sel_hi:[0,1,1] neg_lo:[0,0,1] neg_hi:[0,0,1]
    v_pk_fma_f32 v[188:189], v[208:209], v[204:205], v[196:197] op_sel_hi:[0,1,1] neg_lo:[0,0,1] neg_hi:[0,0,1]
    v_pk_fma_f32 v[190:191], v[208:209], v[206:207], v[198:199] op_sel_hi:[0,1,1] neg_lo:[0,0,1] neg_hi:[0,0,1]
    v_cvt_pk_bf16_f32 v56, v184, v185
    v_cvt_pk_bf16_f32 v57, v186, v187
    v_cvt_pk_bf16_f32 v58, v188, v189
    v_cvt_pk_bf16_f32 v59, v190, v191
    v_pk_fma_f32 v[192:193], v[208:209], v[184:185], v[200:201] op_sel_hi:[0,1,1] neg_lo:[0,0,1] neg_hi:[0,0,1]
    v_pk_fma_f32 v[194:195], v[208:209], v[186:187], v[202:203] op_sel_hi:[0,1,1] neg_lo:[0,0,1] neg_hi:[0,0,1]
    v_pk_fma_f32 v[196:197], v[208:209], v[188:189], v[204:205] op_sel_hi:[0,1,1] neg_lo:[0,0,1] neg_hi:[0,0,1]
    v_pk_fma_f32 v[198:199], v[208:209], v[190:191], v[206:207] op_sel_hi:[0,1,1] neg_lo:[0,0,1] neg_hi:[0,0,1]
    v_cvt_pk_bf16_f32 v60, v192, v193
    v_cvt_pk_bf16_f32 v61, v194, v195
    v_cvt_pk_bf16_f32 v62, v196, v197
    v_cvt_pk_bf16_f32 v63, v198, v199
    v_pk_fma_f32 v[200:201], v[208:209], v[192:193], v[184:185] op_sel_hi:[0,1,1] neg_lo:[0,0,1] neg_hi:[0,0,1]
    v_pk_fma_f32 v[202:203], v[208:209], v[194:195], v[186:187] op_sel_hi:[0,1,1] neg_lo:[0,0,1] neg_hi:[0,0,1]
    v_pk_fma_f32 v[204:205], v[208:209], v[196:197], v[188:189] op_sel_hi:[0,1,1] neg_lo:[0,0,1] neg_hi:[0,0,1]
    v_pk_fma_f32 v[206:207], v[208:209], v[198:199], v[190:191] op_sel_hi:[0,1,1] neg_lo:[0,0,1] neg_hi:[0,0,1]
    v_cvt_pk_bf16_f32 v64, v200, v201
    v_cvt_pk_bf16_f32 v65, v202, v203
    v_cvt_pk_bf16_f32 v66, v204, v205
    v_cvt_pk_bf16_f32 v67, v206, v207
    v_pk_fma_f32 v[184:185], v[208:209], v[200:201], v[192:193] op_sel_hi:[0,1,1] neg_lo:[0,0,1] neg_hi:[0,0,1]
    v_pk_fma_f32 v[186:187], v[208:209], v[202:203], v[194:195] op_sel_hi:[0,1,1] neg_lo:[0,0,1] neg_hi:[0,0,1]
    v_pk_fma_f32 v[188:189], v[208:209], v[204:205], v[196:197] op_sel_hi:[0,1,1] neg_lo:[0,0,1] neg_hi:[0,0,1]
    v_pk_fma_f32 v[190:191], v[208:209], v[206:207], v[198:199] op_sel_hi:[0,1,1] neg_lo:[0,0,1] neg_hi:[0,0,1]
    v_cvt_pk_bf16_f32 v68, v184, v185
    v_cvt_pk_bf16_f32 v69, v186, v187
    v_cvt_pk_bf16_f32 v70, v188, v189
    v_cvt_pk_bf16_f32 v71, v190, v191
    s_and_b32 s41, s52, 7
    s_cmp_eq_u32 s41, 3
    s_cselect_b32 s67, 1, 0
    s_cbranch_scc1 L_nopre
    s_add_u32 m0, s69, 4096
    s_nop 0
    buffer_load_dwordx4 v16, s[20:23], s65 offen offset:0 lds
    buffer_load_dwordx4 v17, s[20:23], s65 offen offset:1024 lds
    buffer_load_dwordx4 v18, s[20:23], s65 offen offset:2048 lds
    buffer_load_dwordx4 v19, s[20:23], s65 offen offset:3072 lds
L_nopre:
    v_bfe_u32 v2, v0, 2, 2
    v_lshlrev_b32 v2, 6, v2
    v_lshl_add_u32 v2, v3, 3, v2
    v_add_u32 v2, 147456, v2
    v_lshl_add_u32 v10, v4, 9, v2
    v_lshl_add_u32 v10, v6, 5, v10
    v_lshrrev_b32 v7, 4, v0
    v_lshl_add_u32 v5, v7, 9, v2
    s_lshr_b32 s44, s3, 1
    v_lshl_add_u32 v5, s44, 5, v5
    v_cvt_f32_u32 v8, v11
    v_mov_b32 v9, 0x3ece6666
    v_fmac_f32 v9, 0x3bcccccd, v8
    s_and_b32 s45, s3, 1
    s_mul_i32 s41, s45, 0x3e800000
    v_lshlrev_b32 v7, 3, v7
    v_cvt_f32_u32 v7, v7
    v_add_f32 v7, 0xc2bf0000, v7
    v_fma_f32 v8, v9, v7, s41
    v_fract_f32 v8, v8
    v_mul_f32 v208, 0x42000000, v9
    v_cos_f32 v208, v208
    v_fmamk_f32 v184, v9, 0x00000000, v8
    v_fmamk_f32 v185, v9, 0x3f800000, v8
    v_fmamk_f32 v186, v9, 0x40000000, v8
    v_fmamk_f32 v187, v9, 0x40400000, v8
    v_fmamk_f32 v188, v9, 0x40800000, v8
    v_fmamk_f32 v189, v9, 0x40a00000, v8
    v_fmamk_f32 v190, v9, 0x40c00000, v8
    v_fmamk_f32 v191, v9, 0x40e00000, v8
    v_cos_f32 v184, v184
    v_cos_f32 v185, v185
    v_cos_f32 v186, v186
    v_cos_f32 v187, v187
    v_cos_f32 v188, v188
    v_cos_f32 v189, v189
    v_cos_f32 v190, v190
    v_cos_f32 v191, v191
    v_fmamk_f32 v192, v9, 0x42000000, v8
    v_fmamk_f32 v193, v9, 0x42040000, v8
    v_fmamk_f32 v194, v9, 0x42080000, v8
    v_fmamk_f32 v195, v9, 0x420c0000, v8
    v_fmamk_f32 v196, v9, 0x42100000, v8
    v_fmamk_f32 v197, v9, 0x42140000, v8
    v_fmamk_f32 v198, v9, 0x42180000, v8
    v_fmamk_f32 v199, v9, 0x421c0000, v8
    v_cos_f32 v192, v192
    v_cos_f32 v193, v193
    v_cos_f32 v194, v194
    v_cos_f32 v195, v195
    v_cos_f32 v196, v196
    v_cos_f32 v197, v197
    v_cos_f32 v198, v198
    v_cos_f32 v199, v199
    v_add_f32 v208, v208, v208
    v_cvt_pk_bf16_f32 v72, v184, v185
    v_cvt_pk_bf16_f32 v73, v186, v187
    v_cvt_pk_bf16_f32 v74, v188, v189
    v_cvt_pk_bf16_f32 v75, v190, v191
    v_cvt_pk_bf16_f32 v76, v192, v193
    v_cvt_pk_bf16_f32 v77, v194, v195
    v_cvt_pk_bf16_f32 v78, v196, v197
    v_cvt_pk_bf16_f32 v79, v198, v199
    v_pk_fma_f32 v[200:201], v[208:209], v[192:193], v[184:185] op_sel_hi:[0,1,1] neg_lo:[0,0,1] neg_hi:[0,0,1]
    v_pk_fma_f32 v[202:203], v[208:209], v[194:195], v[186:187] op_sel_hi:[0,1,1] neg_lo:[0,0,1] neg_hi:[0,0,1]
    v_pk_fma_f32 v[204:205], v[208:209], v[196:197], v[188:189] op_sel_hi:[0,1,1] neg_lo:[0,0,1] neg_hi:[0,0,1]
    v_pk_fma_f32 v[206:207], v[208:209], v[198:199], v[190:191] op_sel_hi:[0,1,1] neg_lo:[0,0,1] neg_hi:[0,0,1]
    v_cvt_pk_bf16_f32 v80, v200, v201
    v_cvt_pk_bf16_f32 v81, v202, v203
    v_cvt_pk_bf16_f32 v82, v204, v205
    v_cvt_pk_bf16_f32 v83, v206, v207
    v_pk_fma_f32 v[184:185], v[208:209], v[200:201], v[192:193] op_sel_hi:[0,1,1] neg_lo:[0,0,1] neg_hi:[0,0,1]
    v_pk_fma_f32 v[186:187], v[208:209], v[202:203], v[194:195] op_sel_hi:[0,1,1] neg_lo:[0,0,1] neg_hi:[0,0,1]
    v_pk_fma_f32 v[188:189], v[208:209], v[204:205], v[196:197] op_sel_hi:[0,1,1] neg_lo:[0,0,1] neg_hi:[0,0,1]
    v_pk_fma_f32 v[190:191], v[208:209], v[206:207], v[198:199] op_sel_hi:[0,1,1] neg_lo:[0,0,1] neg_hi:[0,0,1]
    v_cvt_pk_bf16_f32 v84, v184, v185
    v_cvt_pk_bf16_f32 v85, v186, v187
    v_cvt_pk_bf16_f32 v86, v188, v189
    v_cvt_pk_bf16_f32 v87, v190, v191
    v_pk_fma_f32 v[192:193], v[208:209], v[184:185], v[200:201] op_sel_hi:[0,1,1] neg_lo:[0,0,1] neg_hi:[0,0,1]
    v_pk_fma_f32 v[194:195], v[208:209], v[186:187], v[202:203] op_sel_hi:[0,1,1] neg_lo:[0,0,1] neg_hi:[0,0,1]
    v_pk_fma_f32 v[196:197], v[208:209], v[188:189], v[204:205] op_sel_hi:[0,1,1] neg_lo:[0,0,1] neg_hi:[0,0,1]
    v_pk_fma_f32 v[198:199], v[208:209], v[190:191], v[206:207] op_sel_hi:[0,1,1] neg_lo:[0,0,1] neg_hi:[0,0,1]
    v_cvt_pk_bf16_f32 v88, v192, v193
    v_cvt_pk_bf16_f32 v89, v194, v195
    v_cvt_pk_bf16_f32 v90, v196, v197
    v_cvt_pk_bf16_f32 v91, v198, v199
    v_bfe_u32 v20, v0, 3, 1
    v_lshlrev_b32 v20, 16, v20
    s_lshr_b32 s5, s39, 1
    v_and_b32 v21, 7, v0
    v_xor_b32 v21, s5, v21
    v_lshl_add_u32 v21, v21, 4, v20
    v_lshl_add_u32 v22, v4, 11, v21
    v_lshl_add_u32 v20, v6, 12, v22
    v_xor_b32 v23, 1, v6
    v_lshl_add_u32 v22, v23, 30, v22
    s_lshl_b32 s4, s40, 18
    s_lshl_b32 s5, s39, 7
    s_add_u32 s4, s4, s5
    s_mul_i32 s5, s3, 12288
    s_add_u32 s6, s4, s5
    s_add_u32 s7, s6, 0x20000
    s_add_u32 s8, s6, 4096
    s_add_u32 s9, s7, 4096
    s_mov_b32 s10, 0x80008000
    s_lshl_b32 s44, s44, 17
    s_add_u32 s44, s44, s4
    s_add_u32 s44, s44, 49152
    s_add_u32 s4, s45, 1
    s_lshl_b32 s4, s4, 12
    s_xor_b32 s5, s45, 1
    s_lshl_b32 s5, s5, 30
    s_sub_u32 s5, s5, s4
    v_mul_lo_u32 v23, v4, s5
    v_lshl_add_u32 v21, v6, 11, v21
    v_add3_u32 v11, v21, v23, s4
    s_getreg_b32 s38, hwreg(HW_REG_XCC_ID, 0, 4)
    s_lshr_b32 s4, s15, 4
    s_lshl1_add_u32 s4, s14, s4
    s_lshl_b32 s4, s4, 7
    s_add_u32 s100, s4, 41959424
    v_mov_b32 v254, s38
    s_and_b32 s4, s15, 15
    s_lshl2_add_u32 s4, s4, s100
    s_cmp_eq_u32 s67, 0
    s_waitcnt vmcnt(9)
    s_cbranch_scc1 L_xok
    s_waitcnt vmcnt(5)
L_xok:
    s_waitcnt lgkmcnt(0)
    s_barrier
    ds_read_b64_tr_b16 v[132:133], v5 offset:0
    ds_read_b64_tr_b16 v[134:135], v5 offset:256
    ds_read_b64_tr_b16 v[136:137], v5 offset:2048
    ds_read_b64_tr_b16 v[138:139], v5 offset:2304
    ds_read_b64_tr_b16 v[140:141], v5 offset:4096
    ds_read_b64_tr_b16 v[142:143], v5 offset:4352
    ds_read_b64_tr_b16 v[144:145], v5 offset:6144
    ds_read_b64_tr_b16 v[146:147], v5 offset:6400
    ds_read_b64_tr_b16 v[148:149], v5 offset:8192
    ds_read_b64_tr_b16 v[150:151], v5 offset:8448
    ds_read_b64_tr_b16 v[92:93], v10 offset:0
    ds_read_b64_tr_b16 v[94:95], v10 offset:256
    ds_read_b64_tr_b16 v[96:97], v10 offset:1024
    ds_read_b64_tr_b16 v[98:99], v10 offset:1280
    s_waitcnt lgkmcnt(12)
    v_mfma_f32_16x16x32_bf16 v[176:179], v[132:135], v[72:75], 0
    ds_read_b64_tr_b16 v[100:101], v10 offset:2048
    ds_read_b64_tr_b16 v[102:103], v10 offset:2304
    s_waitcnt lgkmcnt(11)
    v_mfma_f32_16x16x32_bf16 v[176:179], v[136:139], v[76:79], v[176:179]
    ds_read_b64_tr_b16 v[104:105], v10 offset:3072
    ds_read_b64_tr_b16 v[106:107], v10 offset:3328
    s_waitcnt lgkmcnt(9)
    v_mfma_f32_16x16x32_bf16 v[176:179], v[140:143], v[80:83], v[176:179]
    ds_read_b64_tr_b16 v[108:109], v10 offset:4096
    ds_read_b64_tr_b16 v[110:111], v10 offset:4352
    v_mfma_f32_16x16x32_bf16 v[176:179], v[144:147], v[84:87], v[176:179]
    ds_read_b64_tr_b16 v[112:113], v10 offset:5120
    ds_read_b64_tr_b16 v[114:115], v10 offset:5376
    s_waitcnt lgkmcnt(8)
    v_mfma_f32_16x16x32_bf16 v[176:179], v[148:151], v[88:91], v[176:179]
    ds_read_b64_tr_b16 v[116:117], v10 offset:6144
    ds_read_b64_tr_b16 v[118:119], v10 offset:6400
    v_mfma_f32_32x32x16_bf16 v[160:175], v[92:95], v[32:35], 0
    ds_read_b64_tr_b16 v[120:121], v10 offset:7168
    ds_read_b64_tr_b16 v[122:123], v10 offset:7424
    v_mfma_f32_32x32x16_bf16 v[160:175], v[96:99], v[36:39], v[160:175]
    ds_read_b64_tr_b16 v[124:125], v10 offset:8192
    ds_read_b64_tr_b16 v[126:127], v10 offset:8448
    s_waitcnt lgkmcnt(8)
    v_mfma_f32_32x32x16_bf16 v[160:175], v[100:103], v[40:43], v[160:175]
    ds_read_b64_tr_b16 v[128:129], v10 offset:9216
    ds_read_b64_tr_b16 v[130:131], v10 offset:9472
    v_mfma_f32_32x32x16_bf16 v[160:175], v[104:107], v[44:47], v[160:175]
    v_cvt_pk_bf16_f32 v240, v176, v177
    v_cvt_pk_bf16_f32 v241, v178, v179
    v_xor_b32 v242, s10, v240
    v_xor_b32 v243, s10, v241
    v_mfma_f32_32x32x16_bf16 v[160:175], v[108:111], v[48:51], v[160:175]
    v_permlane32_swap_b32 v240, v242
    v_permlane32_swap_b32 v241, v243
    s_waitcnt lgkmcnt(3)
    v_mfma_f32_32x32x16_bf16 v[160:175], v[112:115], v[52:55], v[160:175]
    buffer_store_dwordx4 v[240:243], v11, s[24:27], s44 offen sc1
    v_mfma_f32_32x32x16_bf16 v[160:175], v[116:119], v[56:59], v[160:175]
    v_mfma_f32_32x32x16_bf16 v[160:175], v[120:123], v[60:63], v[160:175]
    s_waitcnt lgkmcnt(0)
    v_mfma_f32_32x32x16_bf16 v[160:175], v[124:127], v[64:67], v[160:175]
    v_mfma_f32_32x32x16_bf16 v[160:175], v[128:131], v[68:71], v[160:175]
    s_cmp_lg_u32 s3, 0
    s_cbranch_scc1 L_xc
    s_mov_b64 exec, 1
    buffer_store_dword v254, off, s[24:27], s4 sc1
    s_mov_b64 exec, -1
L_xc:
    s_nop 9
    v_cvt_pk_bf16_f32 v224, v160, v161
    v_cvt_pk_bf16_f32 v225, v162, v163
    v_cvt_pk_bf16_f32 v226, v164, v165
    v_cvt_pk_bf16_f32 v227, v166, v167
    buffer_store_dwordx4 v[224:227], v20, s[24:27], s8 offen sc1
    v_cvt_pk_bf16_f32 v228, v168, v169
    v_cvt_pk_bf16_f32 v229, v170, v171
    v_cvt_pk_bf16_f32 v230, v172, v173
    v_cvt_pk_bf16_f32 v231, v174, v175
    buffer_store_dwordx4 v[228:231], v20, s[24:27], s9 offen sc1
    v_xor_b32 v232, s10, v224
    v_xor_b32 v233, s10, v225
    v_xor_b32 v234, s10, v226
    v_xor_b32 v235, s10, v227
    buffer_store_dwordx4 v[232:235], v22, s[24:27], s6 offen sc1
    v_xor_b32 v236, s10, v228
    v_xor_b32 v237, s10, v229
    v_xor_b32 v238, s10, v230
    v_xor_b32 v239, s10, v231
    buffer_store_dwordx4 v[236:239], v22, s[24:27], s7 offen sc1
    s_lshl_b32 s64, s64, 15
    s_add_u32 s64, s64, s56
    s_lshr_b32 s70, s48, 2
    s_or_b32 s70, s70, 1
    v_mov_b64 v[24:25], 0
    v_mov_b64 v[26:27], 0
    s_mul_i32 s36, s46, 0x9E3779B1
    s_add_u32 s36, s36, 0x7F4A7C15
    s_mul_i32 s37, s47, 0x85EBCA6B
    s_add_u32 s37, s37, s36
    v_mfma_f32_32x32x16_bf16 a[176:191], v[24:27], v[24:27], 0
    s_mov_b32 s30, 524288
    s_mov_b32 s31, 0x00020000
    s_mov_b32 s34, 2048000
    s_mov_b32 s35, 0x00020000
    s_mul_i32 s41, s3, 3072
    v_lshlrev_b32 v3, 4, v0
    v_add_u32 v3, s41, v3
    s_add_u32 s53, s41, 98304
    v_mfma_f32_32x32x16_bf16 a[112:127], v[24:27], v[24:27], 0
    s_add_u32 s42, s48, 8
    s_cmp_lt_u32 s42, s58
    s_cselect_b32 s60, 0x100001, 1
    s_mov_b32 s61, 0
    s_lshl2_add_u32 s41, s48, 8
    s_lshl_b64 s[60:61], s[60:61], s41
    v_mfma_f32_32x32x16_bf16 a[96:111], v[24:27], v[24:27], 0
    s_and_b32 s41, s48, 1
    s_or_b32 s60, s60, s41
    s_lshl_b64 s[4:5], s[60:61], 4
    s_mov_b32 s41, 0x76543210
    s_cmp_eq_u32 s48, 4
    s_cselect_b32 s41, 0x76543102, s41
    v_mfma_f32_32x32x16_bf16 a[80:95], v[24:27], v[24:27], 0
    s_add_u32 s60, s60, s41
    s_addc_u32 s61, s61, 0xa98
    s_sub_u32 s60, s60, s4
    s_subb_u32 s61, s61, s5
    s_lshl_b64 s[60:61], s[60:61], 11
    v_mfma_f32_32x32x16_bf16 a[64:79], v[24:27], v[24:27], 0
    s_lshl_b32 s55, s43, 17
    s_mul_i32 s41, s48, 12288
    s_add_u32 s55, s55, s41
    v_add_u32 v3, s55, v3
    s_lshl_b32 s45, s62, 17
    v_mfma_f32_32x32x16_bf16 a[48:63], v[24:27], v[24:27], 0
    s_lshr_b32 s63, s43, 1
    s_min_u32 s63, s63, 10
    s_lshl4_add_u32 s63, s14, s63
    s_lshl_b32 s63, s63, 7
    s_add_u32 s63, s63, 41943040
    v_mfma_f32_32x32x16_bf16 a[32:47], v[24:27], v[24:27], 0
    s_lshl_b32 s50, s50, 15
    s_add_u32 s50, s50, s56
    s_lshl_b32 s51, s51, 15
    s_add_u32 s51, s51, s56
    s_add_u32 s57, s56, 98304
    v_mfma_f32_32x32x16_bf16 a[16:31], v[24:27], v[24:27], 0
    v_mfma_f32_32x32x16_bf16 a[0:15], v[24:27], v[24:27], 0
    v_and_b32 v21, 3, v0
    v_bfe_u32 v22, v0, 3, 2
    v_lshl_add_u32 v20, v22, 2, v21
    v_lshl_add_u32 v20, s48, 4, v20
    v_lshl_add_u32 v20, v20, 1, 1
    v_cvt_f32_u32 v20, v20
    v_mul_f32 v20, 0x3b4ccccd, v20
    v_bfe_u32 v22, v0, 2, 1
    v_cvt_f32_u32 v22, v22
    v_mul_f32 v22, 0x3e800000, v22
    v_lshlrev_b32 v23, 3, v4
    v_cvt_f32_u32 v1, v23
    v_fma_f32 v22, v20, v1, v22
    v_fmamk_f32 v32, v20, 0x00000000, v22
    v_fmamk_f32 v33, v20, 0x3f800000, v22
    v_fmamk_f32 v34, v20, 0x40000000, v22
    v_fmamk_f32 v35, v20, 0x40400000, v22
    v_fmamk_f32 v36, v20, 0x40800000, v22
    v_fmamk_f32 v37, v20, 0x40a00000, v22
    v_fmamk_f32 v38, v20, 0x40c00000, v22
    v_fmamk_f32 v39, v20, 0x40e00000, v22
    v_fmamk_f32 v40, v20, 0x41800000, v22
    v_fmamk_f32 v41, v20, 0x41880000, v22
    v_fmamk_f32 v42, v20, 0x41900000, v22
    v_fmamk_f32 v43, v20, 0x41980000, v22
    v_fmamk_f32 v44, v20, 0x41a00000, v22
    v_fmamk_f32 v45, v20, 0x41a80000, v22
    v_fmamk_f32 v46, v20, 0x41b00000, v22
    v_fmamk_f32 v47, v20, 0x41b80000, v22
    v_cos_f32 v32, v32
    v_cos_f32 v33, v33
    v_cos_f32 v34, v34
    v_cos_f32 v35, v35
    v_cos_f32 v36, v36
    v_cos_f32 v37, v37
    v_cos_f32 v38, v38
    v_cos_f32 v39, v39
    v_cos_f32 v40, v40
    v_cos_f32 v41, v41
    v_cos_f32 v42, v42
    v_cos_f32 v43, v43
    v_cos_f32 v44, v44
    v_cos_f32 v45, v45
    v_cos_f32 v46, v46
    v_cos_f32 v47, v47
    v_bfe_u32 v22, v0, 2, 2
    v_add_u32 v23, v23, v22
    v_lshlrev_b32 v1, 10, v23
    v_xor_b32 v22, s3, v22
    v_lshl_add_u32 v1, v22, 5, v1
    v_lshl_add_u32 v1, v6, 7, v1
    v_lshl_add_u32 v1, v21, 3, v1
    v_subrev_u32 v1, s56, v1
    v_add_u32 v2, s50, v1
    v_cvt_pk_bf16_f32 v24, v32, v33
    v_cvt_pk_bf16_f32 v25, v34, v35
    v_cvt_pk_bf16_f32 v26, v36, v37
    v_cvt_pk_bf16_f32 v27, v38, v39
    v_cvt_pk_bf16_f32 v28, v40, v41
    v_cvt_pk_bf16_f32 v29, v42, v43
    v_cvt_pk_bf16_f32 v30, v44, v45
    v_cvt_pk_bf16_f32 v31, v46, v47
    v_sub_u32 v22, 1, v4
    v_lshlrev_b32 v22, 12, v22
    v_lshl_add_u32 v22, v6, 11, v22
    v_and_b32 v21, 15, v0
    v_lshl_add_u32 v22, v21, 7, v22
    v_lshrrev_b32 v21, 1, v21
    v_lshl_add_u32 v22, v21, 4, v22
    v_add_u32 v4, 98304, v22
    v_xor_b32 v5, 16, v4
    v_xor_b32 v6, 32, v4
    v_xor_b32 v7, 48, v4
    v_xor_b32 v8, 64, v4
    v_xor_b32 v9, 80, v4
    v_xor_b32 v10, 96, v4
    v_xor_b32 v11, 112, v4
    v_mov_b64 v[152:153], 0
    v_mov_b64 v[216:217], 0
    v_mov_b64 v[154:155], 0
    v_mov_b64 v[218:219], 0
    v_mov_b64 v[156:157], 0
    v_mov_b64 v[220:221], 0
    v_mov_b64 v[158:159], 0
    v_mov_b64 v[222:223], 0
    v_lshrrev_b32 v21, 3, v0
    v_bfe_u32 v22, v21, 1, 1
    v_lshlrev_b32 v22, 2, v22
    v_and_b32 v23, 7, v0
    v_xor_b32 v22, v22, v23
    v_lshlrev_b32 v21, 10, v21
    v_lshl_add_u32 v244, v22, 4, v21
    v_add_u32 v245, 7168, v244
    v_add_u32 v246, 14336, v244
    v_add_u32 v247, 21504, v244
    s_and_b32 s66, s15, 7
    s_lshl_b32 s66, s66, 7
    s_lshl_b32 s41, s3, 16
    s_add_u32 s66, s66, s41
    v_lshrrev_b32 v21, 4, v0
    v_mul_u32_u24 v248, 3932160, v21
    v_and_b32 v21, 15, v0
    v_lshl_add_u32 v248, v21, 4, v248
    s_lshr_b32 s41, s3, 1
    s_lshl1_add_u32 s11, s52, s41
    s_mul_i32 s11, s11, 3
    s_add_u32 s11, s11, s49
    s_mul_i32 s11, s11, 5
    s_add_u32 s11, s11, s48
    s_and_b32 s41, s3, 1
    s_lshl3_add_u32 s11, s11, s41
    s_lshl_b32 s11, s11, 8
    s_add_u32 s11, s11, 4194304
    s_lshl4_add_u32 s41, s40, s39
    s_lshl_b32 s41, s41, 3
    s_add_u32 s41, s41, 41943040
    v_lshlrev_b32 v21, 11, v0
    v_mov_b32 v22, s36
    v_mov_b32 v23, s37
    s_mov_b32 s12, s41
    s_xor_b32 s13, s3, 1
    s_or_b32 s13, s13, s70
    s_cmp_lg_u32 s3, 1
    s_waitcnt vmcnt(0)
    s_barrier
    s_cbranch_scc1 L_a4
    s_mov_b64 exec, 0xff
    buffer_store_dwordx2 v[22:23], v21, s[24:27], s12 offen sc1
    s_mov_b64 exec, -1
L_a4:
    s_cmp_eq_u32 s70, 0
    s_cbranch_scc1 L_b0
    s_cmp_eq_u32 s67, 0
    s_cbranch_scc1 L_hadpre
    s_add_u32 m0, s69, 4096
    s_nop 0
    buffer_load_dwordx4 v16, s[20:23], s65 offen offset:0 lds
    buffer_load_dwordx4 v17, s[20:23], s65 offen offset:1024 lds
    buffer_load_dwordx4 v18, s[20:23], s65 offen offset:2048 lds
    buffer_load_dwordx4 v19, s[20:23], s65 offen offset:3072 lds
    s_cmp_eq_u32 s59, 1
    s_cbranch_scc1 L_helper
L_hadpre:
    s_xor_b32 s65, s65, 16384
    s_add_u32 m0, s64, 0
    s_nop 0
    buffer_load_dwordx4 v12, s[20:23], s65 offen offset:0 lds
    buffer_load_dwordx4 v13, s[20:23], s65 offen offset:1024 lds
    buffer_load_dwordx4 v14, s[20:23], s65 offen offset:2048 lds
    buffer_load_dwordx4 v15, s[20:23], s65 offen offset:3072 lds
    s_add_u32 m0, s64, 4096
    s_nop 0
    buffer_load_dwordx4 v16, s[20:23], s65 offen offset:0 lds
    buffer_load_dwordx4 v17, s[20:23], s65 offen offset:1024 lds
    buffer_load_dwordx4 v18, s[20:23], s65 offen offset:2048 lds
    buffer_load_dwordx4 v19, s[20:23], s65 offen offset:3072 lds
    s_or_b32 s41, s67, s68
    s_cbranch_scc0 L_b0
    s_cmp_eq_u32 s68, 0
    s_waitcnt vmcnt(8)
    s_cbranch_scc1 L_b0
    s_waitcnt vmcnt(0)
L_b0:
    v_lshrrev_b32 v232, 1, v0
    v_lshlrev_b32 v232, 13, v232
    v_and_b32 v233, 1, v0
    v_lshl_add_u32 v232, v233, 8, v232
    v_lshrrev_b32 v233, 4, v0
    v_lshl_add_u32 v232, v233, 29, v232
    v_mov_b32 v234, s36
    v_mov_b32 v235, s37
    s_lshr_b32 s9, s52, 3
    s_lshl1_add_u32 s9, s49, s9
    s_mul_i32 s9, s9, 5
    s_add_u32 s9, s9, s48
    s_and_b32 s41, s52, 7
    s_lshl_b32 s41, s41, 6
    s_add_u32 s9, s9, s41
    s_lshl_b32 s9, s9, 3
    s_add_u32 s9, s9, 42205184
    s_add_u32 s8, s9, 4096
    s_sub_u32 s42, s58, 1
    s_lshr_b32 s42, s42, 1
    s_bitcmp1_b32 s58, 0
    s_cbranch_scc1 L_other
    v_min_u32 v228, 47, v0
    v_lshlrev_b32 v228, 4, v228
    s_barrier
    s_and_b32 s65, s60, 0x78000
    s_mov_b32 m0, s51
    s_nop 0
    buffer_load_dwordx4 v12, s[20:23], s65 offen offset:0 lds
    ds_read_b64_tr_b16 a[128:129], v2 offset:0
    ds_read_b64_tr_b16 a[130:131], v2 offset:4096
    ds_read_b64_tr_b16 a[132:133], v2 offset:16384
    buffer_load_dwordx4 v13, s[20:23], s65 offen offset:1024 lds
    ds_read_b64_tr_b16 a[134:135], v2 offset:20480
    ds_read_b64_tr_b16 a[136:137], v2 offset:256
    ds_read_b64_tr_b16 a[138:139], v2 offset:4352
    s_waitcnt lgkmcnt(4)
    v_mfma_f32_32x32x16_bf16 v[32:47], v[24:27], a[128:131], 0
    buffer_load_dwordx4 v14, s[20:23], s65 offen offset:2048 lds
    ds_read_b64_tr_b16 a[140:141], v2 offset:16640
    ds_read_b64_tr_b16 a[142:143], v2 offset:20736
    s_waitcnt lgkmcnt(4)
    v_mfma_f32_32x32x16_bf16 v[32:47], v[28:31], a[132:135], v[32:47]
    buffer_load_dwordx4 v15, s[20:23], s65 offen offset:3072 lds
    s_add_u32 m0, s51, 4096
    ds_read_b64_tr_b16 a[144:145], v2 offset:512
    ds_read_b64_tr_b16 a[146:147], v2 offset:4608
    s_xor_b32 s51, s51, s57
    s_xor_b32 s51, s51, s50
    s_waitcnt lgkmcnt(4)
    v_mfma_f32_32x32x16_bf16 v[48:63], v[24:27], a[136:139], 0
    buffer_load_dwordx4 v16, s[20:23], s65 offen offset:0 lds
    ds_read_b64_tr_b16 a[148:149], v2 offset:16896
    ds_read_b64_tr_b16 a[150:151], v2 offset:20992
    s_waitcnt lgkmcnt(4)
    v_mfma_f32_32x32x16_bf16 v[48:63], v[28:31], a[140:143], v[48:63]
    buffer_load_dwordx4 v17, s[20:23], s65 offen offset:1024 lds
    ds_read_b64_tr_b16 a[152:153], v2 offset:768
    ds_read_b64_tr_b16 a[154:155], v2 offset:4864
    s_waitcnt lgkmcnt(4)
    v_mfma_f32_32x32x16_bf16 v[64:79], v[24:27], a[144:147], 0
    buffer_load_dwordx4 v18, s[20:23], s65 offen offset:2048 lds
    ds_read_b64_tr_b16 a[156:157], v2 offset:17152
    ds_read_b64_tr_b16 a[158:159], v2 offset:21248
    s_nop 3
    v_cvt_pk_bf16_f32 v160, v32, v48
    v_cvt_pk_bf16_f32 v164, v33, v49
    v_cvt_pk_bf16_f32 v168, v34, v50
    v_cvt_pk_bf16_f32 v172, v35, v51
    s_waitcnt lgkmcnt(4)
    v_mfma_f32_32x32x16_bf16 v[64:79], v[28:31], a[148:151], v[64:79]
    buffer_load_dwordx4 v19, s[20:23], s65 offen offset:3072 lds
    v_cvt_pk_bf16_f32 v176, v36, v52
    v_cvt_pk_bf16_f32 v180, v37, v53
    v_cvt_pk_bf16_f32 v184, v38, v54
    v_cvt_pk_bf16_f32 v188, v39, v55
    v_add_u32 v2, s51, v1
    s_waitcnt vmcnt(8) lgkmcnt(0)
    s_barrier
    s_add_u32 s62, s65, 16384
    s_lshr_b64 s[60:61], s[60:61], 4
    s_mov_b32 m0, s50
    v_mfma_f32_32x32x16_bf16 v[80:95], v[24:27], a[152:155], 0
    buffer_load_dwordx4 v12, s[20:23], s62 offen offset:0 lds
    ds_read_b64_tr_b16 a[128:129], v2 offset:0
    ds_read_b64_tr_b16 a[130:131], v2 offset:4096
    ds_read_b64_tr_b16 a[132:133], v2 offset:16384
    v_cvt_pk_bf16_f32 v192, v40, v56
    v_cvt_pk_bf16_f32 v196, v41, v57
    v_cvt_pk_bf16_f32 v200, v42, v58
    v_cvt_pk_bf16_f32 v204, v43, v59
    v_mfma_f32_32x32x16_bf16 v[80:95], v[28:31], a[156:159], v[80:95]
    s_cmp_lg_u32 s3, 0
    s_cbranch_scc1 L_pk2
    buffer_load_dwordx4 v[224:227], v228, s[24:27], s63 offen sc1
L_pk2:
    buffer_load_dwordx4 v13, s[20:23], s62 offen offset:1024 lds
    ds_read_b64_tr_b16 a[134:135], v2 offset:20480
    ds_read_b64_tr_b16 a[136:137], v2 offset:256
    ds_read_b64_tr_b16 a[138:139], v2 offset:4352
    v_cvt_pk_bf16_f32 v208, v44, v60
    v_cvt_pk_bf16_f32 v212, v45, v61
    v_cvt_pk_bf16_f32 v216, v46, v62
    v_cvt_pk_bf16_f32 v220, v47, v63
    s_waitcnt lgkmcnt(3)
    v_mfma_f32_32x32x16_bf16 v[32:47], v[24:27], a[128:131], 0
    buffer_load_dwordx4 v14, s[20:23], s62 offen offset:2048 lds
    ds_read_b64_tr_b16 a[140:141], v2 offset:16640
    ds_read_b64_tr_b16 a[142:143], v2 offset:20736
    v_cvt_pk_bf16_f32 v161, v64, v80
    v_cvt_pk_bf16_f32 v165, v65, v81
    v_cvt_pk_bf16_f32 v169, v66, v82
    v_cvt_pk_bf16_f32 v173, v67, v83
    s_waitcnt lgkmcnt(2)
    v_mfma_f32_32x32x16_bf16 v[32:47], v[28:31], a[132:135], v[32:47]
    buffer_load_dwordx4 v15, s[20:23], s62 offen offset:3072 lds
    s_add_u32 m0, s50, 4096
    ds_read_b64_tr_b16 a[144:145], v2 offset:512
    ds_read_b64_tr_b16 a[146:147], v2 offset:4608
    v_cvt_pk_bf16_f32 v177, v68, v84
    v_cvt_pk_bf16_f32 v181, v69, v85
    v_cvt_pk_bf16_f32 v185, v70, v86
    v_cvt_pk_bf16_f32 v189, v71, v87
    s_xor_b32 s50, s50, s57
    s_xor_b32 s50, s50, s51
    v_mfma_f32_32x32x16_bf16 v[48:63], v[24:27], a[136:139], 0
    buffer_load_dwordx4 v16, s[20:23], s62 offen offset:0 lds
    ds_read_b64_tr_b16 a[148:149], v2 offset:16896
    ds_read_b64_tr_b16 a[150:151], v2 offset:20992
    v_cvt_pk_bf16_f32 v193, v72, v88
    v_cvt_pk_bf16_f32 v197, v73, v89
    v_cvt_pk_bf16_f32 v201, v74, v90
    v_cvt_pk_bf16_f32 v205, v75, v91
    s_waitcnt lgkmcnt(2)
    v_mfma_f32_32x32x16_bf16 v[48:63], v[28:31], a[140:143], v[48:63]
    buffer_load_dwordx4 v17, s[20:23], s62 offen offset:1024 lds
    ds_read_b64_tr_b16 a[152:153], v2 offset:768
    ds_read_b64_tr_b16 a[154:155], v2 offset:4864
    v_cvt_pk_bf16_f32 v209, v76, v92
    v_cvt_pk_bf16_f32 v213, v77, v93
    v_cvt_pk_bf16_f32 v217, v78, v94
    v_cvt_pk_bf16_f32 v221, v79, v95
    v_mfma_f32_32x32x16_bf16 v[64:79], v[24:27], a[144:147], 0
    buffer_load_dwordx4 v18, s[20:23], s62 offen offset:2048 lds
    ds_read_b64_tr_b16 a[156:157], v2 offset:17152
    ds_read_b64_tr_b16 a[158:159], v2 offset:21248
    s_nop 0
    v_cvt_pk_bf16_f32 v162, v32, v48
    v_cvt_pk_bf16_f32 v166, v33, v49
    v_cvt_pk_bf16_f32 v170, v34, v50
    v_cvt_pk_bf16_f32 v174, v35, v51
    s_waitcnt lgkmcnt(2)
    v_mfma_f32_32x32x16_bf16 v[64:79], v[28:31], a[148:151], v[64:79]
    buffer_load_dwordx4 v19, s[20:23], s62 offen offset:3072 lds
    v_cvt_pk_bf16_f32 v178, v36, v52
    v_cvt_pk_bf16_f32 v182, v37, v53
    v_cvt_pk_bf16_f32 v186, v38, v54
    v_cvt_pk_bf16_f32 v190, v39, v55
    v_add_u32 v2, s50, v1
    s_lshl_b32 s10, s65, 2
    s_waitcnt lgkmcnt(0)
    s_cmp_lg_u32 s3, 0
    s_cbranch_scc1 L_go2
    s_mov_b32 s38, 0
    s_waitcnt vmcnt(7)
    s_branch L_ja2
L_polla2:
    buffer_load_dwordx4 v[224:227], v228, s[24:27], s63 offen sc1
    s_add_u32 s38, s38, 1
    s_waitcnt vmcnt(0)
L_ja2:
    v_cmp_ne_u64 vcc, s[36:37], v[224:225]
    v_cmp_ne_u64 s[70:71], s[36:37], v[226:227]
    s_nop 1
    s_or_b64 vcc, vcc, s[70:71]
    s_cmp_ge_u32 s38, 1048576
    s_cbranch_scc1 L_go2
    s_cbranch_vccnz L_polla2
L_go2:
    s_add_u32 m0, s53, 24576
    s_barrier
    buffer_load_dwordx4 v3, s[24:27], s45 offen offset:0 sc1 lds
    buffer_load_dwordx4 v3, s[24:27], s45 offen offset:1024 sc1 lds
    buffer_load_dwordx4 v3, s[24:27], s45 offen offset:2048 sc1 lds
    s_add_u32 m0, s53, 36864
    s_add_u32 s45, s45, 0x10000
    buffer_load_dwordx4 v3, s[24:27], s45 offen offset:0 sc1 lds
    buffer_load_dwordx4 v3, s[24:27], s45 offen offset:1024 sc1 lds
    buffer_load_dwordx4 v3, s[24:27], s45 offen offset:2048 sc1 lds
    s_lshl_b32 s45, s65, 2
    s_waitcnt vmcnt(3) lgkmcnt(0)
.p2align 3
L_phase0:
    s_barrier
    v_mfma_f32_32x32x16_bf16 v[80:95], v[24:27], a[152:155], 0
    s_add_u32 m0, s53, 0
    ds_read_b64_tr_b16 a[128:129], v2 offset:0
    ds_read_b64_tr_b16 a[130:131], v2 offset:4096
    ds_read_b64_tr_b16 a[132:133], v2 offset:16384
    v_cvt_pk_bf16_f32 v194, v40, v56
    v_cvt_pk_bf16_f32 v198, v41, v57
    v_cvt_pk_bf16_f32 v202, v42, v58
    v_cvt_pk_bf16_f32 v206, v43, v59
    s_waitcnt lgkmcnt(3)
    v_mfma_f32_16x16x32_bf16 a[112:115], a[176:179], v[152:155], a[112:115]
    ds_read_b128 a[160:163], v4 offset:24576
    buffer_load_dwordx4 v3, s[24:27], s45 offen offset:0 sc1 lds
    v_mfma_f32_16x16x32_bf16 a[116:119], a[180:183], v[152:155], a[116:119]
    ds_read_b128 a[164:167], v4 offset:28672
    s_and_b32 s65, s60, 0x78000
    v_mfma_f32_32x32x16_bf16 v[80:95], v[28:31], a[156:159], v[80:95]
    buffer_load_dwordx4 v3, s[24:27], s45 offen offset:1024 sc1 lds
    ds_read_b64_tr_b16 a[134:135], v2 offset:20480
    ds_read_b64_tr_b16 a[136:137], v2 offset:256
    ds_read_b64_tr_b16 a[138:139], v2 offset:4352
    v_cvt_pk_bf16_f32 v210, v44, v60
    v_cvt_pk_bf16_f32 v214, v45, v61
    v_cvt_pk_bf16_f32 v218, v46, v62
    v_cvt_pk_bf16_f32 v222, v47, v63
    v_mfma_f32_16x16x32_bf16 a[120:123], a[184:187], v[156:159], a[120:123]
    ds_read_b128 a[168:171], v5 offset:24576
    v_mfma_f32_16x16x32_bf16 a[124:127], a[188:191], v[156:159], a[124:127]
    ds_read_b128 a[172:175], v5 offset:28672
    buffer_load_dwordx4 v3, s[24:27], s45 offen offset:2048 sc1 lds
    s_mov_b32 m0, s51
    s_waitcnt lgkmcnt(5)
    v_mfma_f32_32x32x16_bf16 v[32:47], v[24:27], a[128:131], 0
    ds_read_b64_tr_b16 a[140:141], v2 offset:16640
    ds_read_b64_tr_b16 a[142:143], v2 offset:20736
    v_cvt_pk_bf16_f32 v163, v64, v80
    v_cvt_pk_bf16_f32 v167, v65, v81
    v_cvt_pk_bf16_f32 v171, v66, v82
    v_cvt_pk_bf16_f32 v175, v67, v83
    v_mfma_f32_16x16x32_bf16 a[0:3], a[160:163], v[160:163], a[0:3]
    ds_read_b128 a[176:179], v6 offset:24576
    buffer_load_dwordx4 v12, s[20:23], s65 offen offset:0 lds
    v_mfma_f32_16x16x32_bf16 a[4:7], a[164:167], v[160:163], a[4:7]
    ds_read_b128 a[180:183], v6 offset:28672
    s_lshl_b32 s45, s62, 2
    s_waitcnt lgkmcnt(4)
    v_mfma_f32_32x32x16_bf16 v[32:47], v[28:31], a[132:135], v[32:47]
    ds_read_b64_tr_b16 a[144:145], v2 offset:512
    ds_read_b64_tr_b16 a[146:147], v2 offset:4608
    v_cvt_pk_bf16_f32 v179, v68, v84
    v_cvt_pk_bf16_f32 v183, v69, v85
    v_cvt_pk_bf16_f32 v187, v70, v86
    v_cvt_pk_bf16_f32 v191, v71, v87
    v_mfma_f32_16x16x32_bf16 a[8:11], a[168:171], v[164:167], a[8:11]
    ds_read_b128 a[184:187], v7 offset:24576
    buffer_load_dwordx4 v13, s[20:23], s65 offen offset:1024 lds
    v_mfma_f32_16x16x32_bf16 a[12:15], a[172:175], v[164:167], a[12:15]
    ds_read_b128 a[188:191], v7 offset:28672
    v_mfma_f32_32x32x16_bf16 v[48:63], v[24:27], a[136:139], 0
    buffer_load_dwordx4 v14, s[20:23], s65 offen offset:2048 lds
    ds_read_b64_tr_b16 a[148:149], v2 offset:16896
    ds_read_b64_tr_b16 a[150:151], v2 offset:20992
    v_cvt_pk_bf16_f32 v195, v72, v88
    v_cvt_pk_bf16_f32 v199, v73, v89
    v_cvt_pk_bf16_f32 v203, v74, v90
    v_cvt_pk_bf16_f32 v207, v75, v91
    s_waitcnt lgkmcnt(4)
    v_mfma_f32_16x16x32_bf16 a[16:19], a[176:179], v[168:171], a[16:19]
    ds_read_b128 a[160:163], v8 offset:24576
    v_mfma_f32_16x16x32_bf16 a[20:23], a[180:183], v[168:171], a[20:23]
    ds_read_b128 a[164:167], v8 offset:28672
    buffer_load_dwordx4 v15, s[20:23], s65 offen offset:3072 lds
    s_add_u32 m0, s51, 4096
    v_mfma_f32_32x32x16_bf16 v[48:63], v[28:31], a[140:143], v[48:63]
    ds_read_b64_tr_b16 a[152:153], v2 offset:768
    ds_read_b64_tr_b16 a[154:155], v2 offset:4864
    v_cvt_pk_bf16_f32 v211, v76, v92
    v_cvt_pk_bf16_f32 v215, v77, v93
    v_cvt_pk_bf16_f32 v219, v78, v94
    v_cvt_pk_bf16_f32 v223, v79, v95
    s_waitcnt lgkmcnt(4)
    v_mfma_f32_16x16x32_bf16 a[24:27], a[184:187], v[172:175], a[24:27]
    ds_read_b128 a[168:171], v9 offset:24576
    buffer_load_dwordx4 v16, s[20:23], s65 offen offset:0 lds
    v_mfma_f32_16x16x32_bf16 a[28:31], a[188:191], v[172:175], a[28:31]
    ds_read_b128 a[172:175], v9 offset:28672
    s_xor_b32 s51, s51, s57
    v_mfma_f32_32x32x16_bf16 v[64:79], v[24:27], a[144:147], 0
    buffer_load_dwordx4 v17, s[20:23], s65 offen offset:1024 lds
    ds_read_b64_tr_b16 a[156:157], v2 offset:17152
    ds_read_b64_tr_b16 a[158:159], v2 offset:21248
    v_cvt_pk_bf16_f32 v96, v32, v48
    v_cvt_pk_bf16_f32 v100, v33, v49
    v_cvt_pk_bf16_f32 v104, v34, v50
    v_cvt_pk_bf16_f32 v108, v35, v51
    s_waitcnt lgkmcnt(4)
    v_mfma_f32_16x16x32_bf16 a[32:35], a[160:163], v[176:179], a[32:35]
    ds_read_b128 a[176:179], v10 offset:24576
    s_xor_b32 s51, s51, s50
    v_mfma_f32_16x16x32_bf16 a[36:39], a[164:167], v[176:179], a[36:39]
    ds_read_b128 a[180:183], v10 offset:28672
    buffer_load_dwordx4 v18, s[20:23], s65 offen offset:2048 lds
    v_mfma_f32_32x32x16_bf16 v[64:79], v[28:31], a[148:151], v[64:79]
    v_cvt_pk_bf16_f32 v112, v36, v52
    v_cvt_pk_bf16_f32 v116, v37, v53
    v_cvt_pk_bf16_f32 v120, v38, v54
    v_cvt_pk_bf16_f32 v124, v39, v55
    v_add_u32 v2, s51, v1
    s_waitcnt lgkmcnt(2)
    v_mfma_f32_16x16x32_bf16 a[40:43], a[168:171], v[180:183], a[40:43]
    ds_read_b128 a[184:187], v11 offset:24576
    buffer_load_dwordx4 v19, s[20:23], s65 offen offset:3072 lds
    v_mfma_f32_16x16x32_bf16 a[44:47], a[172:175], v[180:183], a[44:47]
    ds_read_b128 a[188:191], v11 offset:28672
    s_waitcnt vmcnt(11) lgkmcnt(4)
    s_barrier
    v_mfma_f32_32x32x16_bf16 v[80:95], v[24:27], a[152:155], 0
    s_add_u32 m0, s53, 12288
    ds_read_b64_tr_b16 a[128:129], v2 offset:0
    ds_read_b64_tr_b16 a[130:131], v2 offset:4096
    ds_read_b64_tr_b16 a[132:133], v2 offset:16384
    v_cvt_pk_bf16_f32 v128, v40, v56
    v_cvt_pk_bf16_f32 v132, v41, v57
    v_cvt_pk_bf16_f32 v136, v42, v58
    v_cvt_pk_bf16_f32 v140, v43, v59
    s_waitcnt lgkmcnt(4)
    v_mfma_f32_16x16x32_bf16 a[48:51], a[176:179], v[184:187], a[48:51]
    ds_read_b128 a[160:163], v4 offset:36864
    buffer_load_dwordx4 v3, s[24:27], s45 offen offset:0 sc1 lds
    v_mfma_f32_16x16x32_bf16 a[52:55], a[180:183], v[184:187], a[52:55]
    ds_read_b128 a[164:167], v4 offset:40960
    s_add_u32 s62, s65, 16384
    v_mfma_f32_32x32x16_bf16 v[80:95], v[28:31], a[156:159], v[80:95]
    buffer_load_dwordx4 v3, s[24:27], s45 offen offset:1024 sc1 lds
    ds_read_b64_tr_b16 a[134:135], v2 offset:20480
    ds_read_b64_tr_b16 a[136:137], v2 offset:256
    ds_read_b64_tr_b16 a[138:139], v2 offset:4352
    v_cvt_pk_bf16_f32 v144, v44, v60
    v_cvt_pk_bf16_f32 v148, v45, v61
    v_cvt_pk_bf16_f32 v152, v46, v62
    v_cvt_pk_bf16_f32 v156, v47, v63
    v_mfma_f32_16x16x32_bf16 a[56:59], a[184:187], v[188:191], a[56:59]
    ds_read_b128 a[168:171], v5 offset:36864
    s_lshr_b64 s[60:61], s[60:61], 4
    s_waitcnt lgkmcnt(4)
    v_mfma_f32_16x16x32_bf16 a[60:63], a[188:191], v[188:191], a[60:63]
    ds_read_b128 a[172:175], v5 offset:40960
    buffer_load_dwordx4 v3, s[24:27], s45 offen offset:2048 sc1 lds
    s_mov_b32 m0, s50
    v_mfma_f32_32x32x16_bf16 v[32:47], v[24:27], a[128:131], 0
    ds_read_b64_tr_b16 a[140:141], v2 offset:16640
    ds_read_b64_tr_b16 a[142:143], v2 offset:20736
    v_cvt_pk_bf16_f32 v97, v64, v80
    v_cvt_pk_bf16_f32 v101, v65, v81
    v_cvt_pk_bf16_f32 v105, v66, v82
    v_cvt_pk_bf16_f32 v109, v67, v83
    v_mfma_f32_16x16x32_bf16 a[64:67], a[160:163], v[192:195], a[64:67]
    ds_read_b128 a[176:179], v6 offset:36864
    buffer_load_dwordx4 v12, s[20:23], s62 offen offset:0 lds
    v_mfma_f32_16x16x32_bf16 a[68:71], a[164:167], v[192:195], a[68:71]
    ds_read_b128 a[180:183], v6 offset:40960
    s_lshl_b32 s45, s65, 2
    s_waitcnt lgkmcnt(4)
    v_mfma_f32_32x32x16_bf16 v[32:47], v[28:31], a[132:135], v[32:47]
    ds_read_b64_tr_b16 a[144:145], v2 offset:512
    ds_read_b64_tr_b16 a[146:147], v2 offset:4608
    v_cvt_pk_bf16_f32 v113, v68, v84
    v_cvt_pk_bf16_f32 v117, v69, v85
    v_cvt_pk_bf16_f32 v121, v70, v86
    v_cvt_pk_bf16_f32 v125, v71, v87
    v_mfma_f32_16x16x32_bf16 a[72:75], a[168:171], v[196:199], a[72:75]
    ds_read_b128 a[184:187], v7 offset:36864
    buffer_load_dwordx4 v13, s[20:23], s62 offen offset:1024 lds
    v_mfma_f32_16x16x32_bf16 a[76:79], a[172:175], v[196:199], a[76:79]
    ds_read_b128 a[188:191], v7 offset:40960
    v_mfma_f32_32x32x16_bf16 v[48:63], v[24:27], a[136:139], 0
    buffer_load_dwordx4 v14, s[20:23], s62 offen offset:2048 lds
    ds_read_b64_tr_b16 a[148:149], v2 offset:16896
    ds_read_b64_tr_b16 a[150:151], v2 offset:20992
    v_cvt_pk_bf16_f32 v129, v72, v88
    v_cvt_pk_bf16_f32 v133, v73, v89
    v_cvt_pk_bf16_f32 v137, v74, v90
    v_cvt_pk_bf16_f32 v141, v75, v91
    s_waitcnt lgkmcnt(4)
    v_mfma_f32_16x16x32_bf16 a[80:83], a[176:179], v[200:203], a[80:83]
    ds_read_b128 a[160:163], v8 offset:36864
    v_mfma_f32_16x16x32_bf16 a[84:87], a[180:183], v[200:203], a[84:87]
    ds_read_b128 a[164:167], v8 offset:40960
    buffer_load_dwordx4 v15, s[20:23], s62 offen offset:3072 lds
    s_add_u32 m0, s50, 4096
    v_mfma_f32_32x32x16_bf16 v[48:63], v[28:31], a[140:143], v[48:63]
    ds_read_b64_tr_b16 a[152:153], v2 offset:768
    ds_read_b64_tr_b16 a[154:155], v2 offset:4864
    v_cvt_pk_bf16_f32 v145, v76, v92
    v_cvt_pk_bf16_f32 v149, v77, v93
    v_cvt_pk_bf16_f32 v153, v78, v94
    v_cvt_pk_bf16_f32 v157, v79, v95
    s_waitcnt lgkmcnt(4)
    v_mfma_f32_16x16x32_bf16 a[88:91], a[184:187], v[204:207], a[88:91]
    ds_read_b128 a[168:171], v9 offset:36864
    buffer_load_dwordx4 v16, s[20:23], s62 offen offset:0 lds
    v_mfma_f32_16x16x32_bf16 a[92:95], a[188:191], v[204:207], a[92:95]
    ds_read_b128 a[172:175], v9 offset:40960
    s_xor_b32 s50, s50, s57
    v_mfma_f32_32x32x16_bf16 v[64:79], v[24:27], a[144:147], 0
    buffer_load_dwordx4 v17, s[20:23], s62 offen offset:1024 lds
    ds_read_b64_tr_b16 a[156:157], v2 offset:17152
    ds_read_b64_tr_b16 a[158:159], v2 offset:21248
    v_cvt_pk_bf16_f32 v98, v32, v48
    v_cvt_pk_bf16_f32 v102, v33, v49
    v_cvt_pk_bf16_f32 v106, v34, v50
    v_cvt_pk_bf16_f32 v110, v35, v51
    s_waitcnt lgkmcnt(4)
    v_mfma_f32_16x16x32_bf16 a[96:99], a[160:163], v[208:211], a[96:99]
    ds_read_b128 a[176:179], v10 offset:36864
    s_xor_b32 s50, s50, s51
    v_mfma_f32_16x16x32_bf16 a[100:103], a[164:167], v[208:211], a[100:103]
    ds_read_b128 a[180:183], v10 offset:40960
    buffer_load_dwordx4 v18, s[20:23], s62 offen offset:2048 lds
    v_mfma_f32_32x32x16_bf16 v[64:79], v[28:31], a[148:151], v[64:79]
    v_cvt_pk_bf16_f32 v114, v36, v52
    v_cvt_pk_bf16_f32 v118, v37, v53
    v_cvt_pk_bf16_f32 v122, v38, v54
    v_cvt_pk_bf16_f32 v126, v39, v55
    v_add_u32 v2, s50, v1
    s_waitcnt lgkmcnt(2)
    v_mfma_f32_16x16x32_bf16 a[104:107], a[168:171], v[212:215], a[104:107]
    ds_read_b128 a[184:187], v11 offset:36864
    buffer_load_dwordx4 v19, s[20:23], s62 offen offset:3072 lds
    v_mfma_f32_16x16x32_bf16 a[108:111], a[172:175], v[212:215], a[108:111]
    ds_read_b128 a[188:191], v11 offset:40960
    s_waitcnt vmcnt(11) lgkmcnt(4)
L_phase2:
    s_barrier
    v_mfma_f32_32x32x16_bf16 v[80:95], v[24:27], a[152:155], 0
    s_add_u32 m0, s53, 24576
    ds_read_b64_tr_b16 a[128:129], v2 offset:0
    ds_read_b64_tr_b16 a[130:131], v2 offset:4096
    ds_read_b64_tr_b16 a[132:133], v2 offset:16384
    v_cvt_pk_bf16_f32 v130, v40, v56
    v_cvt_pk_bf16_f32 v134, v41, v57
    v_cvt_pk_bf16_f32 v138, v42, v58
    v_cvt_pk_bf16_f32 v142, v43, v59
    s_waitcnt lgkmcnt(4)
    v_mfma_f32_16x16x32_bf16 a[112:115], a[176:179], v[216:219], a[112:115]
    ds_read_b128 a[160:163], v4 offset:0
    buffer_load_dwordx4 v3, s[24:27], s45 offen offset:0 sc1 lds
    v_mfma_f32_16x16x32_bf16 a[116:119], a[180:183], v[216:219], a[116:119]
    ds_read_b128 a[164:167], v4 offset:4096
    s_and_b32 s65, s60, 0x78000
    v_mfma_f32_32x32x16_bf16 v[80:95], v[28:31], a[156:159], v[80:95]
    buffer_load_dwordx4 v3, s[24:27], s45 offen offset:1024 sc1 lds
    ds_read_b64_tr_b16 a[134:135], v2 offset:20480
    ds_read_b64_tr_b16 a[136:137], v2 offset:256
    ds_read_b64_tr_b16 a[138:139], v2 offset:4352
    v_cvt_pk_bf16_f32 v146, v44, v60
    v_cvt_pk_bf16_f32 v150, v45, v61
    v_cvt_pk_bf16_f32 v154, v46, v62
    v_cvt_pk_bf16_f32 v158, v47, v63
    v_mfma_f32_16x16x32_bf16 a[120:123], a[184:187], v[220:223], a[120:123]
    ds_read_b128 a[168:171], v5 offset:0
    s_waitcnt lgkmcnt(5)
    v_mfma_f32_16x16x32_bf16 a[124:127], a[188:191], v[220:223], a[124:127]
    ds_read_b128 a[172:175], v5 offset:4096
    buffer_load_dwordx4 v3, s[24:27], s45 offen offset:2048 sc1 lds
    s_mov_b32 m0, s51
    v_mfma_f32_32x32x16_bf16 v[32:47], v[24:27], a[128:131], 0
    ds_read_b64_tr_b16 a[140:141], v2 offset:16640
    ds_read_b64_tr_b16 a[142:143], v2 offset:20736
    v_cvt_pk_bf16_f32 v99, v64, v80
    v_cvt_pk_bf16_f32 v103, v65, v81
    v_cvt_pk_bf16_f32 v107, v66, v82
    v_cvt_pk_bf16_f32 v111, v67, v83
    v_mfma_f32_16x16x32_bf16 a[0:3], a[160:163], v[96:99], a[0:3]
    ds_read_b128 a[176:179], v6 offset:0
    buffer_load_dwordx4 v12, s[20:23], s65 offen offset:0 lds
    s_waitcnt lgkmcnt(4)
    v_mfma_f32_16x16x32_bf16 a[4:7], a[164:167], v[96:99], a[4:7]
    ds_read_b128 a[180:183], v6 offset:4096
    s_lshl_b32 s45, s62, 2
    v_mfma_f32_32x32x16_bf16 v[32:47], v[28:31], a[132:135], v[32:47]
    ds_read_b64_tr_b16 a[144:145], v2 offset:512
    ds_read_b64_tr_b16 a[146:147], v2 offset:4608
    v_cvt_pk_bf16_f32 v115, v68, v84
    v_cvt_pk_bf16_f32 v119, v69, v85
    v_cvt_pk_bf16_f32 v123, v70, v86
    v_cvt_pk_bf16_f32 v127, v71, v87
    v_mfma_f32_16x16x32_bf16 a[8:11], a[168:171], v[100:103], a[8:11]
    ds_read_b128 a[184:187], v7 offset:0
    buffer_load_dwordx4 v13, s[20:23], s65 offen offset:1024 lds
    s_waitcnt lgkmcnt(4)
    v_mfma_f32_16x16x32_bf16 a[12:15], a[172:175], v[100:103], a[12:15]
    ds_read_b128 a[188:191], v7 offset:4096
    v_mfma_f32_32x32x16_bf16 v[48:63], v[24:27], a[136:139], 0
    buffer_load_dwordx4 v14, s[20:23], s65 offen offset:2048 lds
    ds_read_b64_tr_b16 a[148:149], v2 offset:16896
    ds_read_b64_tr_b16 a[150:151], v2 offset:20992
    v_cvt_pk_bf16_f32 v131, v72, v88
    v_cvt_pk_bf16_f32 v135, v73, v89
    v_cvt_pk_bf16_f32 v139, v74, v90
    v_cvt_pk_bf16_f32 v143, v75, v91
    v_mfma_f32_16x16x32_bf16 a[16:19], a[176:179], v[104:107], a[16:19]
    ds_read_b128 a[160:163], v8 offset:0
    s_waitcnt lgkmcnt(4)
    v_mfma_f32_16x16x32_bf16 a[20:23], a[180:183], v[104:107], a[20:23]
    ds_read_b128 a[164:167], v8 offset:4096
    buffer_load_dwordx4 v15, s[20:23], s65 offen offset:3072 lds
    s_add_u32 m0, s51, 4096
    v_mfma_f32_32x32x16_bf16 v[48:63], v[28:31], a[140:143], v[48:63]
    ds_read_b64_tr_b16 a[152:153], v2 offset:768
    ds_read_b64_tr_b16 a[154:155], v2 offset:4864
    v_cvt_pk_bf16_f32 v147, v76, v92
    v_cvt_pk_bf16_f32 v151, v77, v93
    v_cvt_pk_bf16_f32 v155, v78, v94
    v_cvt_pk_bf16_f32 v159, v79, v95
    v_mfma_f32_16x16x32_bf16 a[24:27], a[184:187], v[108:111], a[24:27]
    ds_read_b128 a[168:171], v9 offset:0
    buffer_load_dwordx4 v16, s[20:23], s65 offen offset:0 lds
    s_waitcnt lgkmcnt(4)
    v_mfma_f32_16x16x32_bf16 a[28:31], a[188:191], v[108:111], a[28:31]
    ds_read_b128 a[172:175], v9 offset:4096
    s_xor_b32 s51, s51, s57
    v_mfma_f32_32x32x16_bf16 v[64:79], v[24:27], a[144:147], 0
    buffer_load_dwordx4 v17, s[20:23], s65 offen offset:1024 lds
    ds_read_b64_tr_b16 a[156:157], v2 offset:17152
    ds_read_b64_tr_b16 a[158:159], v2 offset:21248
    v_cvt_pk_bf16_f32 v160, v32, v48
    v_cvt_pk_bf16_f32 v164, v33, v49
    v_cvt_pk_bf16_f32 v168, v34, v50
    v_cvt_pk_bf16_f32 v172, v35, v51
    v_mfma_f32_16x16x32_bf16 a[32:35], a[160:163], v[112:115], a[32:35]
    ds_read_b128 a[176:179], v10 offset:0
    s_xor_b32 s51, s51, s50
    s_waitcnt lgkmcnt(4)
    v_mfma_f32_16x16x32_bf16 a[36:39], a[164:167], v[112:115], a[36:39]
    ds_read_b128 a[180:183], v10 offset:4096
    buffer_load_dwordx4 v18, s[20:23], s65 offen offset:2048 lds
    v_mfma_f32_32x32x16_bf16 v[64:79], v[28:31], a[148:151], v[64:79]
    v_cvt_pk_bf16_f32 v176, v36, v52
    v_cvt_pk_bf16_f32 v180, v37, v53
    v_cvt_pk_bf16_f32 v184, v38, v54
    v_cvt_pk_bf16_f32 v188, v39, v55
    v_add_u32 v2, s51, v1
    v_mfma_f32_16x16x32_bf16 a[40:43], a[168:171], v[116:119], a[40:43]
    ds_read_b128 a[184:187], v11 offset:0
    buffer_load_dwordx4 v19, s[20:23], s65 offen offset:3072 lds
    s_waitcnt lgkmcnt(2)
    v_mfma_f32_16x16x32_bf16 a[44:47], a[172:175], v[116:119], a[44:47]
    ds_read_b128 a[188:191], v11 offset:4096
    s_waitcnt vmcnt(11) lgkmcnt(4)
    s_barrier
    v_mfma_f32_32x32x16_bf16 v[80:95], v[24:27], a[152:155], 0
    s_add_u32 m0, s53, 36864
    ds_read_b64_tr_b16 a[128:129], v2 offset:0
    ds_read_b64_tr_b16 a[130:131], v2 offset:4096
    ds_read_b64_tr_b16 a[132:133], v2 offset:16384
    v_cvt_pk_bf16_f32 v192, v40, v56
    v_cvt_pk_bf16_f32 v196, v41, v57
    v_cvt_pk_bf16_f32 v200, v42, v58
    v_cvt_pk_bf16_f32 v204, v43, v59
    v_mfma_f32_16x16x32_bf16 a[48:51], a[176:179], v[120:123], a[48:51]
    ds_read_b128 a[160:163], v4 offset:12288
    buffer_load_dwordx4 v3, s[24:27], s45 offen offset:0 sc1 lds
    s_waitcnt lgkmcnt(4)
    v_mfma_f32_16x16x32_bf16 a[52:55], a[180:183], v[120:123], a[52:55]
    ds_read_b128 a[164:167], v4 offset:16384
    s_add_u32 s62, s65, 16384
    v_mfma_f32_32x32x16_bf16 v[80:95], v[28:31], a[156:159], v[80:95]
    buffer_load_dwordx4 v3, s[24:27], s45 offen offset:1024 sc1 lds
    ds_read_b64_tr_b16 a[134:135], v2 offset:20480
    ds_read_b64_tr_b16 a[136:137], v2 offset:256
    ds_read_b64_tr_b16 a[138:139], v2 offset:4352
    v_cvt_pk_bf16_f32 v208, v44, v60
    v_cvt_pk_bf16_f32 v212, v45, v61
    v_cvt_pk_bf16_f32 v216, v46, v62
    v_cvt_pk_bf16_f32 v220, v47, v63
    v_mfma_f32_16x16x32_bf16 a[56:59], a[184:187], v[124:127], a[56:59]
    ds_read_b128 a[168:171], v5 offset:12288
    s_lshr_b64 s[60:61], s[60:61], 4
    v_mfma_f32_16x16x32_bf16 a[60:63], a[188:191], v[124:127], a[60:63]
    ds_read_b128 a[172:175], v5 offset:16384
    buffer_load_dwordx4 v3, s[24:27], s45 offen offset:2048 sc1 lds
    s_mov_b32 m0, s50
    s_waitcnt lgkmcnt(4)
    v_mfma_f32_32x32x16_bf16 v[32:47], v[24:27], a[128:131], 0
    ds_read_b64_tr_b16 a[140:141], v2 offset:16640
    ds_read_b64_tr_b16 a[142:143], v2 offset:20736
    v_cvt_pk_bf16_f32 v161, v64, v80
    v_cvt_pk_bf16_f32 v165, v65, v81
    v_cvt_pk_bf16_f32 v169, v66, v82
    v_cvt_pk_bf16_f32 v173, v67, v83
    v_mfma_f32_16x16x32_bf16 a[64:67], a[160:163], v[128:131], a[64:67]
    ds_read_b128 a[176:179], v6 offset:12288
    buffer_load_dwordx4 v12, s[20:23], s62 offen offset:0 lds
    v_mfma_f32_16x16x32_bf16 a[68:71], a[164:167], v[128:131], a[68:71]
    ds_read_b128 a[180:183], v6 offset:16384
    s_lshl_b32 s45, s65, 2
    v_mfma_f32_32x32x16_bf16 v[32:47], v[28:31], a[132:135], v[32:47]
    ds_read_b64_tr_b16 a[144:145], v2 offset:512
    ds_read_b64_tr_b16 a[146:147], v2 offset:4608
    v_cvt_pk_bf16_f32 v177, v68, v84
    v_cvt_pk_bf16_f32 v181, v69, v85
    v_cvt_pk_bf16_f32 v185, v70, v86
    v_cvt_pk_bf16_f32 v189, v71, v87
    s_waitcnt lgkmcnt(4)
    v_mfma_f32_16x16x32_bf16 a[72:75], a[168:171], v[132:135], a[72:75]
    ds_read_b128 a[184:187], v7 offset:12288
    buffer_load_dwordx4 v13, s[20:23], s62 offen offset:1024 lds
    v_mfma_f32_16x16x32_bf16 a[76:79], a[172:175], v[132:135], a[76:79]
    ds_read_b128 a[188:191], v7 offset:16384
    s_sub_u32 s42, s42, 1
    v_mfma_f32_32x32x16_bf16 v[48:63], v[24:27], a[136:139], 0
    buffer_load_dwordx4 v14, s[20:23], s62 offen offset:2048 lds
    ds_read_b64_tr_b16 a[148:149], v2 offset:16896
    ds_read_b64_tr_b16 a[150:151], v2 offset:20992
    v_cvt_pk_bf16_f32 v193, v72, v88
    v_cvt_pk_bf16_f32 v197, v73, v89
    v_cvt_pk_bf16_f32 v201, v74, v90
    v_cvt_pk_bf16_f32 v205, v75, v91
    s_waitcnt lgkmcnt(4)
    v_mfma_f32_16x16x32_bf16 a[80:83], a[176:179], v[136:139], a[80:83]
    ds_read_b128 a[160:163], v8 offset:12288
    v_mfma_f32_16x16x32_bf16 a[84:87], a[180:183], v[136:139], a[84:87]
    ds_read_b128 a[164:167], v8 offset:16384
    buffer_load_dwordx4 v15, s[20:23], s62 offen offset:3072 lds
    s_add_u32 m0, s50, 4096
    v_mfma_f32_32x32x16_bf16 v[48:63], v[28:31], a[140:143], v[48:63]
    ds_read_b64_tr_b16 a[152:153], v2 offset:768
    ds_read_b64_tr_b16 a[154:155], v2 offset:4864
    v_cvt_pk_bf16_f32 v209, v76, v92
    v_cvt_pk_bf16_f32 v213, v77, v93
    v_cvt_pk_bf16_f32 v217, v78, v94
    v_cvt_pk_bf16_f32 v221, v79, v95
    s_waitcnt lgkmcnt(4)
    v_mfma_f32_16x16x32_bf16 a[88:91], a[184:187], v[140:143], a[88:91]
    ds_read_b128 a[168:171], v9 offset:12288
    buffer_load_dwordx4 v16, s[20:23], s62 offen offset:0 lds
    v_mfma_f32_16x16x32_bf16 a[92:95], a[188:191], v[140:143], a[92:95]
    ds_read_b128 a[172:175], v9 offset:16384
    s_xor_b32 s50, s50, s57
    v_mfma_f32_32x32x16_bf16 v[64:79], v[24:27], a[144:147], 0
    buffer_load_dwordx4 v17, s[20:23], s62 offen offset:1024 lds
    ds_read_b64_tr_b16 a[156:157], v2 offset:17152
    ds_read_b64_tr_b16 a[158:159], v2 offset:21248
    v_cvt_pk_bf16_f32 v162, v32, v48
    v_cvt_pk_bf16_f32 v166, v33, v49
    v_cvt_pk_bf16_f32 v170, v34, v50
    v_cvt_pk_bf16_f32 v174, v35, v51
    s_waitcnt lgkmcnt(4)
    v_mfma_f32_16x16x32_bf16 a[96:99], a[160:163], v[144:147], a[96:99]
    ds_read_b128 a[176:179], v10 offset:12288
    s_xor_b32 s50, s50, s51
    v_mfma_f32_16x16x32_bf16 a[100:103], a[164:167], v[144:147], a[100:103]
    ds_read_b128 a[180:183], v10 offset:16384
    buffer_load_dwordx4 v18, s[20:23], s62 offen offset:2048 lds
    v_mfma_f32_32x32x16_bf16 v[64:79], v[28:31], a[148:151], v[64:79]
    v_cvt_pk_bf16_f32 v178, v36, v52
    v_cvt_pk_bf16_f32 v182, v37, v53
    v_cvt_pk_bf16_f32 v186, v38, v54
    v_cvt_pk_bf16_f32 v190, v39, v55
    v_add_u32 v2, s50, v1
    s_waitcnt lgkmcnt(2)
    v_mfma_f32_16x16x32_bf16 a[104:107], a[168:171], v[148:151], a[104:107]
    ds_read_b128 a[184:187], v11 offset:12288
    buffer_load_dwordx4 v19, s[20:23], s62 offen offset:3072 lds
    v_mfma_f32_16x16x32_bf16 a[108:111], a[172:175], v[148:151], a[108:111]
    ds_read_b128 a[188:191], v11 offset:16384
    s_cmp_lg_u32 s42, 0
    s_waitcnt vmcnt(11) lgkmcnt(4)
    s_cbranch_scc1 L_phase0
    s_waitcnt lgkmcnt(0)
    s_mov_b32 m0, s53
    s_barrier
    v_mfma_f32_32x32x16_bf16 v[80:95], v[24:27], a[152:155], 0
    ds_read_b64_tr_b16 a[128:129], v2 offset:0
    ds_read_b64_tr_b16 a[130:131], v2 offset:4096
    ds_read_b64_tr_b16 a[132:133], v2 offset:16384
    v_cvt_pk_bf16_f32 v194, v40, v56
    v_cvt_pk_bf16_f32 v198, v41, v57
    v_cvt_pk_bf16_f32 v202, v42, v58
    v_cvt_pk_bf16_f32 v206, v43, v59
    v_mfma_f32_16x16x32_bf16 a[112:115], a[176:179], v[152:155], a[112:115]
    ds_read_b128 a[160:163], v4 offset:24576
    buffer_load_dwordx4 v3, s[24:27], s45 offen offset:0 sc1 lds
    v_mfma_f32_16x16x32_bf16 a[116:119], a[180:183], v[152:155], a[116:119]
    ds_read_b128 a[164:167], v4 offset:28672
    v_mfma_f32_32x32x16_bf16 v[80:95], v[28:31], a[156:159], v[80:95]
    buffer_load_dwordx4 v3, s[24:27], s45 offen offset:1024 sc1 lds
    ds_read_b64_tr_b16 a[134:135], v2 offset:20480
    ds_read_b64_tr_b16 a[136:137], v2 offset:256
    ds_read_b64_tr_b16 a[138:139], v2 offset:4352
    v_cvt_pk_bf16_f32 v210, v44, v60
    v_cvt_pk_bf16_f32 v214, v45, v61
    v_cvt_pk_bf16_f32 v218, v46, v62
    v_cvt_pk_bf16_f32 v222, v47, v63
    v_mfma_f32_16x16x32_bf16 a[120:123], a[184:187], v[156:159], a[120:123]
    ds_read_b128 a[168:171], v5 offset:24576
    v_mfma_f32_16x16x32_bf16 a[124:127], a[188:191], v[156:159], a[124:127]
    ds_read_b128 a[172:175], v5 offset:28672
    buffer_load_dwordx4 v3, s[24:27], s45 offen offset:2048 sc1 lds
    s_lshl_b32 s45, s62, 2
    s_add_u32 m0, s53, 12288
    s_waitcnt lgkmcnt(4)
    v_mfma_f32_32x32x16_bf16 v[32:47], v[24:27], a[128:131], 0
    ds_read_b64_tr_b16 a[140:141], v2 offset:16640
    ds_read_b64_tr_b16 a[142:143], v2 offset:20736
    v_cvt_pk_bf16_f32 v163, v64, v80
    v_cvt_pk_bf16_f32 v167, v65, v81
    v_cvt_pk_bf16_f32 v171, v66, v82
    v_cvt_pk_bf16_f32 v175, v67, v83
    v_mfma_f32_16x16x32_bf16 a[0:3], a[160:163], v[160:163], a[0:3]
    ds_read_b128 a[176:179], v6 offset:24576
    buffer_load_dwordx4 v3, s[24:27], s45 offen offset:0 sc1 lds
    v_mfma_f32_16x16x32_bf16 a[4:7], a[164:167], v[160:163], a[4:7]
    ds_read_b128 a[180:183], v6 offset:28672
    v_mfma_f32_32x32x16_bf16 v[32:47], v[28:31], a[132:135], v[32:47]
    ds_read_b64_tr_b16 a[144:145], v2 offset:512
    ds_read_b64_tr_b16 a[146:147], v2 offset:4608
    v_cvt_pk_bf16_f32 v179, v68, v84
    v_cvt_pk_bf16_f32 v183, v69, v85
    v_cvt_pk_bf16_f32 v187, v70, v86
    v_cvt_pk_bf16_f32 v191, v71, v87
    s_waitcnt lgkmcnt(4)
    v_mfma_f32_16x16x32_bf16 a[8:11], a[168:171], v[164:167], a[8:11]
    ds_read_b128 a[184:187], v7 offset:24576
    buffer_load_dwordx4 v3, s[24:27], s45 offen offset:1024 sc1 lds
    v_mfma_f32_16x16x32_bf16 a[12:15], a[172:175], v[164:167], a[12:15]
    ds_read_b128 a[188:191], v7 offset:28672
    v_mfma_f32_32x32x16_bf16 v[48:63], v[24:27], a[136:139], 0
    buffer_load_dwordx4 v3, s[24:27], s45 offen offset:2048 sc1 lds
    s_mov_b32 m0, s56
    ds_read_b64_tr_b16 a[148:149], v2 offset:16896
    ds_read_b64_tr_b16 a[150:151], v2 offset:20992
    v_cvt_pk_bf16_f32 v195, v72, v88
    v_cvt_pk_bf16_f32 v199, v73, v89
    v_cvt_pk_bf16_f32 v203, v74, v90
    v_cvt_pk_bf16_f32 v207, v75, v91
    s_waitcnt lgkmcnt(4)
    v_mfma_f32_16x16x32_bf16 a[16:19], a[176:179], v[168:171], a[16:19]
    ds_read_b128 a[160:163], v8 offset:24576
    v_mfma_f32_16x16x32_bf16 a[20:23], a[180:183], v[168:171], a[20:23]
    ds_read_b128 a[164:167], v8 offset:28672
    buffer_load_dwordx4 v244, s[28:31], s66 offen offset:0 lds
    v_mfma_f32_32x32x16_bf16 v[48:63], v[28:31], a[140:143], v[48:63]
    ds_read_b64_tr_b16 a[152:153], v2 offset:768
    ds_read_b64_tr_b16 a[154:155], v2 offset:4864
    v_cvt_pk_bf16_f32 v211, v76, v92
    v_cvt_pk_bf16_f32 v215, v77, v93
    v_cvt_pk_bf16_f32 v219, v78, v94
    v_cvt_pk_bf16_f32 v223, v79, v95
    s_waitcnt lgkmcnt(4)
    v_mfma_f32_16x16x32_bf16 a[24:27], a[184:187], v[172:175], a[24:27]
    ds_read_b128 a[168:171], v9 offset:24576
    buffer_load_dwordx4 v245, s[28:31], s66 offen offset:1024 lds
    v_mfma_f32_16x16x32_bf16 a[28:31], a[188:191], v[172:175], a[28:31]
    ds_read_b128 a[172:175], v9 offset:28672
    s_xor_b32 s51, s51, s57
    v_mfma_f32_32x32x16_bf16 v[64:79], v[24:27], a[144:147], 0
    buffer_load_dwordx4 v246, s[28:31], s66 offen offset:2048 lds
    ds_read_b64_tr_b16 a[156:157], v2 offset:17152
    ds_read_b64_tr_b16 a[158:159], v2 offset:21248
    v_cvt_pk_bf16_f32 v96, v32, v48
    v_cvt_pk_bf16_f32 v100, v33, v49
    v_cvt_pk_bf16_f32 v104, v34, v50
    v_cvt_pk_bf16_f32 v108, v35, v51
    s_waitcnt lgkmcnt(4)
    v_mfma_f32_16x16x32_bf16 a[32:35], a[160:163], v[176:179], a[32:35]
    ds_read_b128 a[176:179], v10 offset:24576
    s_xor_b32 s51, s51, s50
    v_mfma_f32_16x16x32_bf16 a[36:39], a[164:167], v[176:179], a[36:39]
    ds_read_b128 a[180:183], v10 offset:28672
    buffer_load_dwordx4 v247, s[28:31], s66 offen offset:3072 lds
    s_add_u32 m0, s56, 4096
    s_add_u32 s66, s66, 32768
    v_mfma_f32_32x32x16_bf16 v[64:79], v[28:31], a[148:151], v[64:79]
    v_cvt_pk_bf16_f32 v112, v36, v52
    v_cvt_pk_bf16_f32 v116, v37, v53
    v_cvt_pk_bf16_f32 v120, v38, v54
    v_cvt_pk_bf16_f32 v124, v39, v55
    v_add_u32 v2, s51, v1
    s_waitcnt lgkmcnt(2)
    v_mfma_f32_16x16x32_bf16 a[40:43], a[168:171], v[180:183], a[40:43]
    ds_read_b128 a[184:187], v11 offset:24576
    buffer_load_dwordx4 v244, s[28:31], s66 offen offset:0 lds
    v_mfma_f32_16x16x32_bf16 a[44:47], a[172:175], v[180:183], a[44:47]
    ds_read_b128 a[188:191], v11 offset:28672
    s_waitcnt vmcnt(11) lgkmcnt(4)
    s_barrier
    v_mfma_f32_32x32x16_bf16 v[80:95], v[24:27], a[152:155], 0
    ds_read_b64_tr_b16 a[128:129], v2 offset:0
    ds_read_b64_tr_b16 a[130:131], v2 offset:4096
    ds_read_b64_tr_b16 a[132:133], v2 offset:16384
    v_cvt_pk_bf16_f32 v128, v40, v56
    v_cvt_pk_bf16_f32 v132, v41, v57
    v_cvt_pk_bf16_f32 v136, v42, v58
    v_cvt_pk_bf16_f32 v140, v43, v59
    s_waitcnt lgkmcnt(4)
    v_mfma_f32_16x16x32_bf16 a[48:51], a[176:179], v[184:187], a[48:51]
    ds_read_b128 a[160:163], v4 offset:36864
    buffer_load_dwordx4 v245, s[28:31], s66 offen offset:1024 lds
    v_mfma_f32_16x16x32_bf16 a[52:55], a[180:183], v[184:187], a[52:55]
    ds_read_b128 a[164:167], v4 offset:40960
    v_mfma_f32_32x32x16_bf16 v[80:95], v[28:31], a[156:159], v[80:95]
    buffer_load_dwordx4 v246, s[28:31], s66 offen offset:2048 lds
    ds_read_b64_tr_b16 a[134:135], v2 offset:20480
    ds_read_b64_tr_b16 a[136:137], v2 offset:256
    ds_read_b64_tr_b16 a[138:139], v2 offset:4352
    v_cvt_pk_bf16_f32 v144, v44, v60
    v_cvt_pk_bf16_f32 v148, v45, v61
    v_cvt_pk_bf16_f32 v152, v46, v62
    v_cvt_pk_bf16_f32 v156, v47, v63
    v_mfma_f32_16x16x32_bf16 a[56:59], a[184:187], v[188:191], a[56:59]
    ds_read_b128 a[168:171], v5 offset:36864
    s_waitcnt lgkmcnt(5)
    v_mfma_f32_16x16x32_bf16 a[60:63], a[188:191], v[188:191], a[60:63]
    ds_read_b128 a[172:175], v5 offset:40960
    buffer_load_dwordx4 v247, s[28:31], s66 offen offset:3072 lds
    s_add_u32 m0, s56, 32768
    s_add_u32 s66, s66, 229376
    v_mfma_f32_32x32x16_bf16 v[32:47], v[24:27], a[128:131], 0
    ds_read_b64_tr_b16 a[140:141], v2 offset:16640
    ds_read_b64_tr_b16 a[142:143], v2 offset:20736
    v_cvt_pk_bf16_f32 v97, v64, v80
    v_cvt_pk_bf16_f32 v101, v65, v81
    v_cvt_pk_bf16_f32 v105, v66, v82
    v_cvt_pk_bf16_f32 v109, v67, v83
    v_mfma_f32_16x16x32_bf16 a[64:67], a[160:163], v[192:195], a[64:67]
    ds_read_b128 a[176:179], v6 offset:36864
    buffer_load_dwordx4 v244, s[28:31], s66 offen offset:0 lds
    s_waitcnt lgkmcnt(3)
    v_mfma_f32_16x16x32_bf16 a[68:71], a[164:167], v[192:195], a[68:71]
    ds_read_b128 a[180:183], v6 offset:40960
    v_mfma_f32_32x32x16_bf16 v[32:47], v[28:31], a[132:135], v[32:47]
    ds_read_b64_tr_b16 a[144:145], v2 offset:512
    ds_read_b64_tr_b16 a[146:147], v2 offset:4608
    v_cvt_pk_bf16_f32 v113, v68, v84
    v_cvt_pk_bf16_f32 v117, v69, v85
    v_cvt_pk_bf16_f32 v121, v70, v86
    v_cvt_pk_bf16_f32 v125, v71, v87
    v_mfma_f32_16x16x32_bf16 a[72:75], a[168:171], v[196:199], a[72:75]
    ds_read_b128 a[184:187], v7 offset:36864
    buffer_load_dwordx4 v245, s[28:31], s66 offen offset:1024 lds
    v_mfma_f32_16x16x32_bf16 a[76:79], a[172:175], v[196:199], a[76:79]
    ds_read_b128 a[188:191], v7 offset:40960
    v_mfma_f32_32x32x16_bf16 v[48:63], v[24:27], a[136:139], 0
    buffer_load_dwordx4 v246, s[28:31], s66 offen offset:2048 lds
    ds_read_b64_tr_b16 a[148:149], v2 offset:16896
    ds_read_b64_tr_b16 a[150:151], v2 offset:20992
    v_cvt_pk_bf16_f32 v129, v72, v88
    v_cvt_pk_bf16_f32 v133, v73, v89
    v_cvt_pk_bf16_f32 v137, v74, v90
    v_cvt_pk_bf16_f32 v141, v75, v91
    s_waitcnt lgkmcnt(4)
    v_mfma_f32_16x16x32_bf16 a[80:83], a[176:179], v[200:203], a[80:83]
    ds_read_b128 a[160:163], v8 offset:36864
    v_mfma_f32_16x16x32_bf16 a[84:87], a[180:183], v[200:203], a[84:87]
    ds_read_b128 a[164:167], v8 offset:40960
    buffer_load_dwordx4 v247, s[28:31], s66 offen offset:3072 lds
    s_add_u32 m0, s56, 36864
    s_add_u32 s66, s66, 32768
    v_mfma_f32_32x32x16_bf16 v[48:63], v[28:31], a[140:143], v[48:63]
    ds_read_b64_tr_b16 a[152:153], v2 offset:768
    ds_read_b64_tr_b16 a[154:155], v2 offset:4864
    v_cvt_pk_bf16_f32 v145, v76, v92
    v_cvt_pk_bf16_f32 v149, v77, v93
    v_cvt_pk_bf16_f32 v153, v78, v94
    v_cvt_pk_bf16_f32 v157, v79, v95
    s_waitcnt lgkmcnt(4)
    v_mfma_f32_16x16x32_bf16 a[88:91], a[184:187], v[204:207], a[88:91]
    ds_read_b128 a[168:171], v9 offset:36864
    buffer_load_dwordx4 v244, s[28:31], s66 offen offset:0 lds
    v_mfma_f32_16x16x32_bf16 a[92:95], a[188:191], v[204:207], a[92:95]
    ds_read_b128 a[172:175], v9 offset:40960
    s_xor_b32 s50, s50, s57
    v_mfma_f32_32x32x16_bf16 v[64:79], v[24:27], a[144:147], 0
    buffer_load_dwordx4 v245, s[28:31], s66 offen offset:1024 lds
    ds_read_b64_tr_b16 a[156:157], v2 offset:17152
    ds_read_b64_tr_b16 a[158:159], v2 offset:21248
    v_cvt_pk_bf16_f32 v98, v32, v48
    v_cvt_pk_bf16_f32 v102, v33, v49
    v_cvt_pk_bf16_f32 v106, v34, v50
    v_cvt_pk_bf16_f32 v110, v35, v51
    s_waitcnt lgkmcnt(4)
    v_mfma_f32_16x16x32_bf16 a[96:99], a[160:163], v[208:211], a[96:99]
    ds_read_b128 a[176:179], v10 offset:36864
    s_xor_b32 s50, s50, s51
    v_mfma_f32_16x16x32_bf16 a[100:103], a[164:167], v[208:211], a[100:103]
    ds_read_b128 a[180:183], v10 offset:40960
    buffer_load_dwordx4 v246, s[28:31], s66 offen offset:2048 lds
    v_mfma_f32_32x32x16_bf16 v[64:79], v[28:31], a[148:151], v[64:79]
    v_cvt_pk_bf16_f32 v114, v36, v52
    v_cvt_pk_bf16_f32 v118, v37, v53
    v_cvt_pk_bf16_f32 v122, v38, v54
    v_cvt_pk_bf16_f32 v126, v39, v55
    v_add_u32 v2, s50, v1
    s_waitcnt lgkmcnt(2)
    v_mfma_f32_16x16x32_bf16 a[104:107], a[168:171], v[212:215], a[104:107]
    ds_read_b128 a[184:187], v11 offset:36864
    buffer_load_dwordx4 v247, s[28:31], s66 offen offset:3072 lds
    v_mfma_f32_16x16x32_bf16 a[108:111], a[172:175], v[212:215], a[108:111]
    ds_read_b128 a[188:191], v11 offset:40960
    s_waitcnt vmcnt(16)
    s_barrier
    v_mfma_f32_32x32x16_bf16 v[80:95], v[24:27], a[152:155], 0
    v_cvt_pk_bf16_f32 v130, v40, v56
    v_cvt_pk_bf16_f32 v134, v41, v57
    v_cvt_pk_bf16_f32 v138, v42, v58
    v_cvt_pk_bf16_f32 v142, v43, v59
    s_waitcnt lgkmcnt(2)
    v_mfma_f32_16x16x32_bf16 a[112:115], a[176:179], v[216:219], a[112:115]
    ds_read_b128 a[160:163], v4 offset:0
    v_mfma_f32_16x16x32_bf16 a[116:119], a[180:183], v[216:219], a[116:119]
    ds_read_b128 a[164:167], v4 offset:4096
    v_mfma_f32_32x32x16_bf16 v[80:95], v[28:31], a[156:159], v[80:95]
    v_cvt_pk_bf16_f32 v146, v44, v60
    v_cvt_pk_bf16_f32 v150, v45, v61
    v_cvt_pk_bf16_f32 v154, v46, v62
    v_cvt_pk_bf16_f32 v158, v47, v63
    s_waitcnt lgkmcnt(2)
    v_mfma_f32_16x16x32_bf16 a[120:123], a[184:187], v[220:223], a[120:123]
    ds_read_b128 a[168:171], v5 offset:0
    v_mfma_f32_16x16x32_bf16 a[124:127], a[188:191], v[220:223], a[124:127]
    ds_read_b128 a[172:175], v5 offset:4096
    s_nop 2
    v_cvt_pk_bf16_f32 v99, v64, v80
    v_cvt_pk_bf16_f32 v103, v65, v81
    v_cvt_pk_bf16_f32 v107, v66, v82
    v_cvt_pk_bf16_f32 v111, v67, v83
    s_waitcnt lgkmcnt(2)
    v_mfma_f32_16x16x32_bf16 a[0:3], a[160:163], v[96:99], a[0:3]
    ds_read_b128 a[176:179], v6 offset:0
    v_mfma_f32_16x16x32_bf16 a[4:7], a[164:167], v[96:99], a[4:7]
    ds_read_b128 a[180:183], v6 offset:4096
    v_cvt_pk_bf16_f32 v115, v68, v84
    v_cvt_pk_bf16_f32 v119, v69, v85
    v_cvt_pk_bf16_f32 v123, v70, v86
    v_cvt_pk_bf16_f32 v127, v71, v87
    s_waitcnt lgkmcnt(2)
    v_mfma_f32_16x16x32_bf16 a[8:11], a[168:171], v[100:103], a[8:11]
    ds_read_b128 a[184:187], v7 offset:0
    v_mfma_f32_16x16x32_bf16 a[12:15], a[172:175], v[100:103], a[12:15]
    ds_read_b128 a[188:191], v7 offset:4096
    v_cvt_pk_bf16_f32 v131, v72, v88
    v_cvt_pk_bf16_f32 v135, v73, v89
    v_cvt_pk_bf16_f32 v139, v74, v90
    v_cvt_pk_bf16_f32 v143, v75, v91
    s_waitcnt lgkmcnt(2)
    v_mfma_f32_16x16x32_bf16 a[16:19], a[176:179], v[104:107], a[16:19]
    ds_read_b128 a[160:163], v8 offset:0
    v_mfma_f32_16x16x32_bf16 a[20:23], a[180:183], v[104:107], a[20:23]
    ds_read_b128 a[164:167], v8 offset:4096
    v_cvt_pk_bf16_f32 v147, v76, v92
    v_cvt_pk_bf16_f32 v151, v77, v93
    v_cvt_pk_bf16_f32 v155, v78, v94
    v_cvt_pk_bf16_f32 v159, v79, v95
    s_waitcnt lgkmcnt(2)
    v_mfma_f32_16x16x32_bf16 a[24:27], a[184:187], v[108:111], a[24:27]
    ds_read_b128 a[168:171], v9 offset:0
    v_mfma_f32_16x16x32_bf16 a[28:31], a[188:191], v[108:111], a[28:31]
    ds_read_b128 a[172:175], v9 offset:4096
    s_waitcnt lgkmcnt(3)
    v_mfma_f32_16x16x32_bf16 a[32:35], a[160:163], v[112:115], a[32:35]
    ds_read_b128 a[176:179], v10 offset:0
    s_waitcnt lgkmcnt(3)
    v_mfma_f32_16x16x32_bf16 a[36:39], a[164:167], v[112:115], a[36:39]
    ds_read_b128 a[180:183], v10 offset:4096
    s_waitcnt lgkmcnt(3)
    v_mfma_f32_16x16x32_bf16 a[40:43], a[168:171], v[116:119], a[40:43]
    ds_read_b128 a[184:187], v11 offset:0
    s_waitcnt lgkmcnt(3)
    v_mfma_f32_16x16x32_bf16 a[44:47], a[172:175], v[116:119], a[44:47]
    ds_read_b128 a[188:191], v11 offset:4096
    s_waitcnt lgkmcnt(3)
    v_mfma_f32_16x16x32_bf16 a[48:51], a[176:179], v[120:123], a[48:51]
    ds_read_b128 a[160:163], v4 offset:12288
    s_waitcnt lgkmcnt(3)
    v_mfma_f32_16x16x32_bf16 a[52:55], a[180:183], v[120:123], a[52:55]
    ds_read_b128 a[164:167], v4 offset:16384
    s_waitcnt lgkmcnt(3)
    v_mfma_f32_16x16x32_bf16 a[56:59], a[184:187], v[124:127], a[56:59]
    ds_read_b128 a[168:171], v5 offset:12288
    s_waitcnt lgkmcnt(3)
    v_mfma_f32_16x16x32_bf16 a[60:63], a[188:191], v[124:127], a[60:63]
    ds_read_b128 a[172:175], v5 offset:16384
    s_add_u32 s10, s11, 0
    v_accvgpr_read_b32 v72, a0
    v_accvgpr_read_b32 v73, a8
    v_accvgpr_read_b32 v74, a16
    v_accvgpr_read_b32 v75, a24
    v_accvgpr_read_b32 v76, a32
    v_accvgpr_read_b32 v77, a40
    v_accvgpr_read_b32 v78, a48
    v_accvgpr_read_b32 v79, a56
    s_waitcnt lgkmcnt(2)
    v_mfma_f32_16x16x32_bf16 a[64:67], a[160:163], v[128:131], a[64:67]
    ds_read_b128 a[176:179], v6 offset:12288
    v_mfma_f32_16x16x32_bf16 a[68:71], a[164:167], v[128:131], a[68:71]
    ds_read_b128 a[180:183], v6 offset:16384
    v_cvt_pk_bf16_f32 v96, v72, v73
    v_cvt_pk_bf16_f32 v97, v74, v75
    v_cvt_pk_bf16_f32 v98, v76, v77
    v_cvt_pk_bf16_f32 v99, v78, v79
    s_waitcnt lgkmcnt(2)
    v_mfma_f32_16x16x32_bf16 a[72:75], a[168:171], v[132:135], a[72:75]
    ds_read_b128 a[184:187], v7 offset:12288
    v_mfma_f32_16x16x32_bf16 a[76:79], a[172:175], v[132:135], a[76:79]
    ds_read_b128 a[188:191], v7 offset:16384
    buffer_store_dwordx4 v[96:99], v248, s[24:27], s10 offen offset:0 sc1
    s_add_u32 s10, s11, 0
    v_accvgpr_read_b32 v80, a4
    v_accvgpr_read_b32 v81, a12
    v_accvgpr_read_b32 v82, a20
    v_accvgpr_read_b32 v83, a28
    v_accvgpr_read_b32 v84, a36
    v_accvgpr_read_b32 v85, a44
    v_accvgpr_read_b32 v86, a52
    v_accvgpr_read_b32 v87, a60
    s_waitcnt lgkmcnt(2)
    v_mfma_f32_16x16x32_bf16 a[80:83], a[176:179], v[136:139], a[80:83]
    ds_read_b128 a[160:163], v8 offset:12288
    v_mfma_f32_16x16x32_bf16 a[84:87], a[180:183], v[136:139], a[84:87]
    ds_read_b128 a[164:167], v8 offset:16384
    v_cvt_pk_bf16_f32 v100, v80, v81
    v_cvt_pk_bf16_f32 v101, v82, v83
    v_cvt_pk_bf16_f32 v102, v84, v85
    v_cvt_pk_bf16_f32 v103, v86, v87
    s_waitcnt lgkmcnt(2)
    v_mfma_f32_16x16x32_bf16 a[88:91], a[184:187], v[140:143], a[88:91]
    ds_read_b128 a[168:171], v9 offset:12288
    v_mfma_f32_16x16x32_bf16 a[92:95], a[188:191], v[140:143], a[92:95]
    ds_read_b128 a[172:175], v9 offset:16384
    buffer_store_dwordx4 v[100:103], v248, s[24:27], s10 offen offset:512 sc1
    s_add_u32 s10, s11, 1966080
    v_accvgpr_read_b32 v72, a2
    v_accvgpr_read_b32 v73, a10
    v_accvgpr_read_b32 v74, a18
    v_accvgpr_read_b32 v75, a26
    v_accvgpr_read_b32 v76, a34
    v_accvgpr_read_b32 v77, a42
    v_accvgpr_read_b32 v78, a50
    v_accvgpr_read_b32 v79, a58
    s_waitcnt lgkmcnt(2)
    v_mfma_f32_16x16x32_bf16 a[96:99], a[160:163], v[144:147], a[96:99]
    ds_read_b128 a[176:179], v10 offset:12288
    v_mfma_f32_16x16x32_bf16 a[100:103], a[164:167], v[144:147], a[100:103]
    ds_read_b128 a[180:183], v10 offset:16384
    v_cvt_pk_bf16_f32 v104, v72, v73
    v_cvt_pk_bf16_f32 v105, v74, v75
    v_cvt_pk_bf16_f32 v106, v76, v77
    v_cvt_pk_bf16_f32 v107, v78, v79
    s_waitcnt lgkmcnt(2)
    v_mfma_f32_16x16x32_bf16 a[104:107], a[168:171], v[148:151], a[104:107]
    ds_read_b128 a[184:187], v11 offset:12288
    v_mfma_f32_16x16x32_bf16 a[108:111], a[172:175], v[148:151], a[108:111]
    ds_read_b128 a[188:191], v11 offset:16384
    buffer_store_dwordx4 v[104:107], v248, s[24:27], s10 offen offset:0 sc1
    s_add_u32 s10, s11, 1966080
    v_accvgpr_read_b32 v80, a6
    v_accvgpr_read_b32 v81, a14
    v_accvgpr_read_b32 v82, a22
    v_accvgpr_read_b32 v83, a30
    v_accvgpr_read_b32 v84, a38
    v_accvgpr_read_b32 v85, a46
    v_accvgpr_read_b32 v86, a54
    v_accvgpr_read_b32 v87, a62
    s_waitcnt lgkmcnt(2)
    v_mfma_f32_16x16x32_bf16 a[112:115], a[176:179], v[152:155], a[112:115]
    v_mfma_f32_16x16x32_bf16 a[116:119], a[180:183], v[152:155], a[116:119]
    v_cvt_pk_bf16_f32 v108, v80, v81
    v_cvt_pk_bf16_f32 v109, v82, v83
    v_cvt_pk_bf16_f32 v110, v84, v85
    v_cvt_pk_bf16_f32 v111, v86, v87
    s_waitcnt lgkmcnt(0)
    v_mfma_f32_16x16x32_bf16 a[120:123], a[184:187], v[156:159], a[120:123]
    v_mfma_f32_16x16x32_bf16 a[124:127], a[188:191], v[156:159], a[124:127]
    buffer_store_dwordx4 v[108:111], v248, s[24:27], s10 offen offset:512 sc1
    s_add_u32 s10, s11, 0
    v_accvgpr_read_b32 v72, a64
    v_accvgpr_read_b32 v73, a72
    v_accvgpr_read_b32 v74, a80
    v_accvgpr_read_b32 v75, a88
    v_accvgpr_read_b32 v76, a96
    v_accvgpr_read_b32 v77, a104
    v_accvgpr_read_b32 v78, a112
    v_accvgpr_read_b32 v79, a120
    v_cvt_pk_bf16_f32 v112, v72, v73
    v_cvt_pk_bf16_f32 v113, v74, v75
    v_cvt_pk_bf16_f32 v114, v76, v77
    v_cvt_pk_bf16_f32 v115, v78, v79
    buffer_store_dwordx4 v[112:115], v248, s[24:27], s10 offen offset:1024 sc1
    s_add_u32 s10, s11, 0
    v_accvgpr_read_b32 v80, a68
    v_accvgpr_read_b32 v81, a76
    v_accvgpr_read_b32 v82, a84
    v_accvgpr_read_b32 v83, a92
    v_accvgpr_read_b32 v84, a100
    v_accvgpr_read_b32 v85, a108
    v_accvgpr_read_b32 v86, a116
    v_accvgpr_read_b32 v87, a124
    v_cvt_pk_bf16_f32 v116, v80, v81
    v_cvt_pk_bf16_f32 v117, v82, v83
    v_cvt_pk_bf16_f32 v118, v84, v85
    v_cvt_pk_bf16_f32 v119, v86, v87
    buffer_store_dwordx4 v[116:119], v248, s[24:27], s10 offen offset:1536 sc1
    s_add_u32 s10, s11, 1966080
    v_accvgpr_read_b32 v72, a66
    v_accvgpr_read_b32 v73, a74
    v_accvgpr_read_b32 v74, a82
    v_accvgpr_read_b32 v75, a90
    v_accvgpr_read_b32 v76, a98
    v_accvgpr_read_b32 v77, a106
    v_accvgpr_read_b32 v78, a114
    v_accvgpr_read_b32 v79, a122
    v_cvt_pk_bf16_f32 v120, v72, v73
    v_cvt_pk_bf16_f32 v121, v74, v75
    v_cvt_pk_bf16_f32 v122, v76, v77
    v_cvt_pk_bf16_f32 v123, v78, v79
    buffer_store_dwordx4 v[120:123], v248, s[24:27], s10 offen offset:1024 sc1
    s_add_u32 s10, s11, 1966080
    v_accvgpr_read_b32 v80, a70
    v_accvgpr_read_b32 v81, a78
    v_accvgpr_read_b32 v82, a86
    v_accvgpr_read_b32 v83, a94
    v_accvgpr_read_b32 v84, a102
    v_accvgpr_read_b32 v85, a110
    v_accvgpr_read_b32 v86, a118
    v_accvgpr_read_b32 v87, a126
    v_cvt_pk_bf16_f32 v124, v80, v81
    v_cvt_pk_bf16_f32 v125, v82, v83
    v_cvt_pk_bf16_f32 v126, v84, v85
    v_cvt_pk_bf16_f32 v127, v86, v87
    buffer_store_dwordx4 v[124:127], v248, s[24:27], s10 offen offset:1536 sc1
    s_add_u32 s10, s11, 983040
    v_accvgpr_read_b32 v72, a1
    v_accvgpr_read_b32 v73, a9
    v_accvgpr_read_b32 v74, a17
    v_accvgpr_read_b32 v75, a25
    v_accvgpr_read_b32 v76, a33
    v_accvgpr_read_b32 v77, a41
    v_accvgpr_read_b32 v78, a49
    v_accvgpr_read_b32 v79, a57
    v_cvt_pk_bf16_f32 v128, v72, v73
    v_cvt_pk_bf16_f32 v129, v74, v75
    v_cvt_pk_bf16_f32 v130, v76, v77
    v_cvt_pk_bf16_f32 v131, v78, v79
    buffer_store_dwordx4 v[128:131], v248, s[24:27], s10 offen offset:0 sc1
    s_add_u32 s10, s11, 983040
    v_accvgpr_read_b32 v80, a5
    v_accvgpr_read_b32 v81, a13
    v_accvgpr_read_b32 v82, a21
    v_accvgpr_read_b32 v83, a29
    v_accvgpr_read_b32 v84, a37
    v_accvgpr_read_b32 v85, a45
    v_accvgpr_read_b32 v86, a53
    v_accvgpr_read_b32 v87, a61
    v_cvt_pk_bf16_f32 v132, v80, v81
    v_cvt_pk_bf16_f32 v133, v82, v83
    v_cvt_pk_bf16_f32 v134, v84, v85
    v_cvt_pk_bf16_f32 v135, v86, v87
    buffer_store_dwordx4 v[132:135], v248, s[24:27], s10 offen offset:512 sc1
    s_add_u32 s10, s11, 2949120
    v_accvgpr_read_b32 v72, a3
    v_accvgpr_read_b32 v73, a11
    v_accvgpr_read_b32 v74, a19
    v_accvgpr_read_b32 v75, a27
    v_accvgpr_read_b32 v76, a35
    v_accvgpr_read_b32 v77, a43
    v_accvgpr_read_b32 v78, a51
    v_accvgpr_read_b32 v79, a59
    v_cvt_pk_bf16_f32 v136, v72, v73
    v_cvt_pk_bf16_f32 v137, v74, v75
    v_cvt_pk_bf16_f32 v138, v76, v77
    v_cvt_pk_bf16_f32 v139, v78, v79
    buffer_store_dwordx4 v[136:139], v248, s[24:27], s10 offen offset:0 sc1
    s_add_u32 s10, s11, 2949120
    v_accvgpr_read_b32 v80, a7
    v_accvgpr_read_b32 v81, a15
    v_accvgpr_read_b32 v82, a23
    v_accvgpr_read_b32 v83, a31
    v_accvgpr_read_b32 v84, a39
    v_accvgpr_read_b32 v85, a47
    v_accvgpr_read_b32 v86, a55
    v_accvgpr_read_b32 v87, a63
    v_cvt_pk_bf16_f32 v140, v80, v81
    v_cvt_pk_bf16_f32 v141, v82, v83
    v_cvt_pk_bf16_f32 v142, v84, v85
    v_cvt_pk_bf16_f32 v143, v86, v87
    buffer_store_dwordx4 v[140:143], v248, s[24:27], s10 offen offset:512 sc1
    s_add_u32 s10, s11, 983040
    v_accvgpr_read_b32 v72, a65
    v_accvgpr_read_b32 v73, a73
    v_accvgpr_read_b32 v74, a81
    v_accvgpr_read_b32 v75, a89
    v_accvgpr_read_b32 v76, a97
    v_accvgpr_read_b32 v77, a105
    v_accvgpr_read_b32 v78, a113
    v_accvgpr_read_b32 v79, a121
    v_cvt_pk_bf16_f32 v144, v72, v73
    v_cvt_pk_bf16_f32 v145, v74, v75
    v_cvt_pk_bf16_f32 v146, v76, v77
    v_cvt_pk_bf16_f32 v147, v78, v79
    buffer_store_dwordx4 v[144:147], v248, s[24:27], s10 offen offset:1024 sc1
    s_add_u32 s10, s11, 983040
    v_accvgpr_read_b32 v80, a69
    v_accvgpr_read_b32 v81, a77
    v_accvgpr_read_b32 v82, a85
    v_accvgpr_read_b32 v83, a93
    v_accvgpr_read_b32 v84, a101
    v_accvgpr_read_b32 v85, a109
    v_accvgpr_read_b32 v86, a117
    v_accvgpr_read_b32 v87, a125
    v_cvt_pk_bf16_f32 v148, v80, v81
    v_cvt_pk_bf16_f32 v149, v82, v83
    v_cvt_pk_bf16_f32 v150, v84, v85
    v_cvt_pk_bf16_f32 v151, v86, v87
    buffer_store_dwordx4 v[148:151], v248, s[24:27], s10 offen offset:1536 sc1
    s_cmp_lg_u32 s3, 1
    s_waitcnt vmcnt(6)
    s_barrier
    s_cbranch_scc1 L_stg
    buffer_store_dwordx2 v[234:235], v232, s[24:27], s9 offen sc1
L_stg:
    s_add_u32 s10, s11, 2949120
    v_accvgpr_read_b32 v72, a67
    v_accvgpr_read_b32 v73, a75
    v_accvgpr_read_b32 v74, a83
    v_accvgpr_read_b32 v75, a91
    v_accvgpr_read_b32 v76, a99
    v_accvgpr_read_b32 v77, a107
    v_accvgpr_read_b32 v78, a115
    v_accvgpr_read_b32 v79, a123
    v_cvt_pk_bf16_f32 v152, v72, v73
    v_cvt_pk_bf16_f32 v153, v74, v75
    v_cvt_pk_bf16_f32 v154, v76, v77
    v_cvt_pk_bf16_f32 v155, v78, v79
    buffer_store_dwordx4 v[152:155], v248, s[24:27], s10 offen offset:1024 sc1
    s_add_u32 s10, s11, 2949120
    v_accvgpr_read_b32 v80, a71
    v_accvgpr_read_b32 v81, a79
    v_accvgpr_read_b32 v82, a87
    v_accvgpr_read_b32 v83, a95
    v_accvgpr_read_b32 v84, a103
    v_accvgpr_read_b32 v85, a111
    v_accvgpr_read_b32 v86, a119
    v_accvgpr_read_b32 v87, a127
    v_cvt_pk_bf16_f32 v156, v80, v81
    v_cvt_pk_bf16_f32 v157, v82, v83
    v_cvt_pk_bf16_f32 v158, v84, v85
    v_cvt_pk_bf16_f32 v159, v86, v87
    buffer_store_dwordx4 v[156:159], v248, s[24:27], s10 offen offset:1536 sc1
    s_branch L_phasec
L_other:
    v_min_u32 v228, 47, v0
    v_lshlrev_b32 v228, 4, v228
    s_barrier
    s_and_b32 s65, s60, 0x78000
    s_mov_b32 m0, s51
    s_nop 0
    buffer_load_dwordx4 v12, s[20:23], s65 offen offset:0 lds
    ds_read_b64_tr_b16 a[128:129], v2 offset:0
    ds_read_b64_tr_b16 a[130:131], v2 offset:4096
    ds_read_b64_tr_b16 a[132:133], v2 offset:16384
    buffer_load_dwordx4 v13, s[20:23], s65 offen offset:1024 lds
    ds_read_b64_tr_b16 a[134:135], v2 offset:20480
    ds_read_b64_tr_b16 a[136:137], v2 offset:256
    ds_read_b64_tr_b16 a[138:139], v2 offset:4352
    s_waitcnt lgkmcnt(4)
    v_mfma_f32_32x32x16_bf16 v[32:47], v[24:27], a[128:131], 0
    buffer_load_dwordx4 v14, s[20:23], s65 offen offset:2048 lds
    ds_read_b64_tr_b16 a[140:141], v2 offset:16640
    ds_read_b64_tr_b16 a[142:143], v2 offset:20736
    s_waitcnt lgkmcnt(4)
    v_mfma_f32_32x32x16_bf16 v[32:47], v[28:31], a[132:135], v[32:47]
    buffer_load_dwordx4 v15, s[20:23], s65 offen offset:3072 lds
    s_add_u32 m0, s51, 4096
    ds_read_b64_tr_b16 a[144:145], v2 offset:512
    ds_read_b64_tr_b16 a[146:147], v2 offset:4608
    s_xor_b32 s51, s51, s57
    s_xor_b32 s51, s51, s50
    s_waitcnt lgkmcnt(4)
    v_mfma_f32_32x32x16_bf16 v[48:63], v[24:27], a[136:139], 0
    buffer_load_dwordx4 v16, s[20:23], s65 offen offset:0 lds
    ds_read_b64_tr_b16 a[148:149], v2 offset:16896
    ds_read_b64_tr_b16 a[150:151], v2 offset:20992
    s_waitcnt lgkmcnt(4)
    v_mfma_f32_32x32x16_bf16 v[48:63], v[28:31], a[140:143], v[48:63]
    buffer_load_dwordx4 v17, s[20:23], s65 offen offset:1024 lds
    ds_read_b64_tr_b16 a[152:153], v2 offset:768
    ds_read_b64_tr_b16 a[154:155], v2 offset:4864
    s_waitcnt lgkmcnt(4)
    v_mfma_f32_32x32x16_bf16 v[64:79], v[24:27], a[144:147], 0
    buffer_load_dwordx4 v18, s[20:23], s65 offen offset:2048 lds
    ds_read_b64_tr_b16 a[156:157], v2 offset:17152
    ds_read_b64_tr_b16 a[158:159], v2 offset:21248
    s_nop 3
    v_cvt_pk_bf16_f32 v96, v32, v48
    v_cvt_pk_bf16_f32 v100, v33, v49
    v_cvt_pk_bf16_f32 v104, v34, v50
    v_cvt_pk_bf16_f32 v108, v35, v51
    s_waitcnt lgkmcnt(4)
    v_mfma_f32_32x32x16_bf16 v[64:79], v[28:31], a[148:151], v[64:79]
    buffer_load_dwordx4 v19, s[20:23], s65 offen offset:3072 lds
    v_cvt_pk_bf16_f32 v112, v36, v52
    v_cvt_pk_bf16_f32 v116, v37, v53
    v_cvt_pk_bf16_f32 v120, v38, v54
    v_cvt_pk_bf16_f32 v124, v39, v55
    v_add_u32 v2, s51, v1
    s_waitcnt vmcnt(8) lgkmcnt(0)
    s_barrier
    s_add_u32 s62, s65, 16384
    s_lshr_b64 s[60:61], s[60:61], 4
    s_mov_b32 m0, s50
    v_mfma_f32_32x32x16_bf16 v[80:95], v[24:27], a[152:155], 0
    buffer_load_dwordx4 v12, s[20:23], s62 offen offset:0 lds
    ds_read_b64_tr_b16 a[128:129], v2 offset:0
    ds_read_b64_tr_b16 a[130:131], v2 offset:4096
    ds_read_b64_tr_b16 a[132:133], v2 offset:16384
    v_cvt_pk_bf16_f32 v128, v40, v56
    v_cvt_pk_bf16_f32 v132, v41, v57
    v_cvt_pk_bf16_f32 v136, v42, v58
    v_cvt_pk_bf16_f32 v140, v43, v59
    v_mfma_f32_32x32x16_bf16 v[80:95], v[28:31], a[156:159], v[80:95]
    s_cmp_lg_u32 s3, 0
    s_cbranch_scc1 L_pk0
    buffer_load_dwordx4 v[224:227], v228, s[24:27], s63 offen sc1
L_pk0:
    buffer_load_dwordx4 v13, s[20:23], s62 offen offset:1024 lds
    ds_read_b64_tr_b16 a[134:135], v2 offset:20480
    ds_read_b64_tr_b16 a[136:137], v2 offset:256
    ds_read_b64_tr_b16 a[138:139], v2 offset:4352
    v_cvt_pk_bf16_f32 v144, v44, v60
    v_cvt_pk_bf16_f32 v148, v45, v61
    v_cvt_pk_bf16_f32 v152, v46, v62
    v_cvt_pk_bf16_f32 v156, v47, v63
    s_waitcnt lgkmcnt(3)
    v_mfma_f32_32x32x16_bf16 v[32:47], v[24:27], a[128:131], 0
    buffer_load_dwordx4 v14, s[20:23], s62 offen offset:2048 lds
    ds_read_b64_tr_b16 a[140:141], v2 offset:16640
    ds_read_b64_tr_b16 a[142:143], v2 offset:20736
    v_cvt_pk_bf16_f32 v97, v64, v80
    v_cvt_pk_bf16_f32 v101, v65, v81
    v_cvt_pk_bf16_f32 v105, v66, v82
    v_cvt_pk_bf16_f32 v109, v67, v83
    s_waitcnt lgkmcnt(2)
    v_mfma_f32_32x32x16_bf16 v[32:47], v[28:31], a[132:135], v[32:47]
    buffer_load_dwordx4 v15, s[20:23], s62 offen offset:3072 lds
    s_add_u32 m0, s50, 4096
    ds_read_b64_tr_b16 a[144:145], v2 offset:512
    ds_read_b64_tr_b16 a[146:147], v2 offset:4608
    v_cvt_pk_bf16_f32 v113, v68, v84
    v_cvt_pk_bf16_f32 v117, v69, v85
    v_cvt_pk_bf16_f32 v121, v70, v86
    v_cvt_pk_bf16_f32 v125, v71, v87
    s_xor_b32 s50, s50, s57
    s_xor_b32 s50, s50, s51
    v_mfma_f32_32x32x16_bf16 v[48:63], v[24:27], a[136:139], 0
    buffer_load_dwordx4 v16, s[20:23], s62 offen offset:0 lds
    ds_read_b64_tr_b16 a[148:149], v2 offset:16896
    ds_read_b64_tr_b16 a[150:151], v2 offset:20992
    v_cvt_pk_bf16_f32 v129, v72, v88
    v_cvt_pk_bf16_f32 v133, v73, v89
    v_cvt_pk_bf16_f32 v137, v74, v90
    v_cvt_pk_bf16_f32 v141, v75, v91
    s_waitcnt lgkmcnt(2)
    v_mfma_f32_32x32x16_bf16 v[48:63], v[28:31], a[140:143], v[48:63]
    buffer_load_dwordx4 v17, s[20:23], s62 offen offset:1024 lds
    ds_read_b64_tr_b16 a[152:153], v2 offset:768
    ds_read_b64_tr_b16 a[154:155], v2 offset:4864
    v_cvt_pk_bf16_f32 v145, v76, v92
    v_cvt_pk_bf16_f32 v149, v77, v93
    v_cvt_pk_bf16_f32 v153, v78, v94
    v_cvt_pk_bf16_f32 v157, v79, v95
    v_mfma_f32_32x32x16_bf16 v[64:79], v[24:27], a[144:147], 0
    buffer_load_dwordx4 v18, s[20:23], s62 offen offset:2048 lds
    ds_read_b64_tr_b16 a[156:157], v2 offset:17152
    ds_read_b64_tr_b16 a[158:159], v2 offset:21248
    s_nop 0
    v_cvt_pk_bf16_f32 v98, v32, v48
    v_cvt_pk_bf16_f32 v102, v33, v49
    v_cvt_pk_bf16_f32 v106, v34, v50
    v_cvt_pk_bf16_f32 v110, v35, v51
    s_waitcnt lgkmcnt(2)
    v_mfma_f32_32x32x16_bf16 v[64:79], v[28:31], a[148:151], v[64:79]
    buffer_load_dwordx4 v19, s[20:23], s62 offen offset:3072 lds
    v_cvt_pk_bf16_f32 v114, v36, v52
    v_cvt_pk_bf16_f32 v118, v37, v53
    v_cvt_pk_bf16_f32 v122, v38, v54
    v_cvt_pk_bf16_f32 v126, v39, v55
    v_add_u32 v2, s50, v1
    s_lshl_b32 s10, s65, 2
    s_waitcnt lgkmcnt(0)
    s_cmp_lg_u32 s3, 0
    s_cbranch_scc1 L_go0
    s_mov_b32 s38, 0
    s_waitcnt vmcnt(7)
    s_branch L_ja0
L_polla0:
    buffer_load_dwordx4 v[224:227], v228, s[24:27], s63 offen sc1
    s_add_u32 s38, s38, 1
    s_waitcnt vmcnt(0)
L_ja0:
    v_cmp_ne_u64 vcc, s[36:37], v[224:225]
    v_cmp_ne_u64 s[70:71], s[36:37], v[226:227]
    s_nop 1
    s_or_b64 vcc, vcc, s[70:71]
    s_cmp_ge_u32 s38, 1048576
    s_cbranch_scc1 L_go0
    s_cbranch_vccnz L_polla0
L_go0:
    s_add_u32 m0, s53, 0
    s_barrier
    buffer_load_dwordx4 v3, s[24:27], s45 offen offset:0 sc1 lds
    buffer_load_dwordx4 v3, s[24:27], s45 offen offset:1024 sc1 lds
    buffer_load_dwordx4 v3, s[24:27], s45 offen offset:2048 sc1 lds
    s_add_u32 m0, s53, 12288
    s_add_u32 s45, s45, 0x10000
    buffer_load_dwordx4 v3, s[24:27], s45 offen offset:0 sc1 lds
    buffer_load_dwordx4 v3, s[24:27], s45 offen offset:1024 sc1 lds
    buffer_load_dwordx4 v3, s[24:27], s45 offen offset:2048 sc1 lds
    s_lshl_b32 s45, s65, 2
    s_waitcnt vmcnt(3) lgkmcnt(0)
    s_branch L_phase2
L_helper:
    s_and_b32 s41, s15, 1
    s_lshl_b32 s41, s41, 3
    s_add_u32 s41, s41, s14
    s_lshl_b32 s41, s41, 2
    s_add_u32 s41, s41, s3
    s_and_b32 s42, s41, 7
    s_lshl_b32 s42, s42, 2
    s_lshr_b32 s43, s41, 3
    v_lshrrev_b32 v21, 4, v0
    v_add_u32 v21, s42, v21
    v_lshlrev_b32 v21, 20, v21
    v_and_b32 v22, 15, v0
    v_lshl_add_u32 v21, v22, 11, v21
    s_add_u32 s44, s43, 0
    s_mul_i32 s45, s44, 43
    s_lshr_b32 s45, s45, 8
    s_mul_i32 s46, s45, 6
    s_sub_u32 s46, s44, s46
    s_lshr_b32 s47, s46, 1
    s_mul_i32 s47, s47, 11
    s_add_u32 s45, s45, s47
    s_lshl_b32 s45, s45, 15
    s_and_b32 s46, s46, 1
    s_lshl_b32 s46, s46, 10
    s_add_u32 s45, s45, s46
    s_add_u32 s45, s45, 98688
    buffer_load_dword v32, v21, s[20:23], s45 offen
    s_add_u32 s44, s43, 8
    s_mul_i32 s45, s44, 43
    s_lshr_b32 s45, s45, 8
    s_mul_i32 s46, s45, 6
    s_sub_u32 s46, s44, s46
    s_lshr_b32 s47, s46, 1
    s_mul_i32 s47, s47, 11
    s_add_u32 s45, s45, s47
    s_lshl_b32 s45, s45, 15
    s_and_b32 s46, s46, 1
    s_lshl_b32 s46, s46, 10
    s_add_u32 s45, s45, s46
    s_add_u32 s45, s45, 98688
    buffer_load_dword v33, v21, s[20:23], s45 offen
    s_add_u32 s44, s43, 16
    s_mul_i32 s45, s44, 43
    s_lshr_b32 s45, s45, 8
    s_mul_i32 s46, s45, 6
    s_sub_u32 s46, s44, s46
    s_lshr_b32 s47, s46, 1
    s_mul_i32 s47, s47, 11
    s_add_u32 s45, s45, s47
    s_lshl_b32 s45, s45, 15
    s_and_b32 s46, s46, 1
    s_lshl_b32 s46, s46, 10
    s_add_u32 s45, s45, s46
    s_add_u32 s45, s45, 98688
    buffer_load_dword v34, v21, s[20:23], s45 offen
    s_add_u32 s44, s43, 24
    s_mul_i32 s45, s44, 43
    s_lshr_b32 s45, s45, 8
    s_mul_i32 s46, s45, 6
    s_sub_u32 s46, s44, s46
    s_lshr_b32 s47, s46, 1
    s_mul_i32 s47, s47, 11
    s_add_u32 s45, s45, s47
    s_lshl_b32 s45, s45, 15
    s_and_b32 s46, s46, 1
    s_lshl_b32 s46, s46, 10
    s_add_u32 s45, s45, s46
    s_add_u32 s45, s45, 98688
    buffer_load_dword v35, v21, s[20:23], s45 offen
    s_add_u32 s44, s43, 32
    s_mul_i32 s45, s44, 43
    s_lshr_b32 s45, s45, 8
    s_mul_i32 s46, s45, 6
    s_sub_u32 s46, s44, s46
    s_lshr_b32 s47, s46, 1
    s_mul_i32 s47, s47, 11
    s_add_u32 s45, s45, s47
    s_lshl_b32 s45, s45, 15
    s_and_b32 s46, s46, 1
    s_lshl_b32 s46, s46, 10
    s_add_u32 s45, s45, s46
    s_add_u32 s45, s45, 98688
    buffer_load_dword v36, v21, s[20:23], s45 offen
    s_add_u32 s44, s43, 40
    s_mul_i32 s45, s44, 43
    s_lshr_b32 s45, s45, 8
    s_mul_i32 s46, s45, 6
    s_sub_u32 s46, s44, s46
    s_lshr_b32 s47, s46, 1
    s_cmp_eq_u32 s47, 2
    s_cselect_b32 s44, 7, 8
    s_cmp_ge_u32 s45, s44
    s_cbranch_scc1 L_hs5
    s_mul_i32 s47, s47, 11
    s_add_u32 s45, s45, s47
    s_lshl_b32 s45, s45, 15
    s_and_b32 s46, s46, 1
    s_lshl_b32 s46, s46, 10
    s_add_u32 s45, s45, s46
    s_add_u32 s45, s45, 98688
    buffer_load_dword v37, v21, s[20:23], s45 offen
L_hs5:
L_h1:
    s_lshl_b32 s45, s41, 13
    s_add_u32 s45, s45, 41943040
    v_lshlrev_b32 v21, 7, v0
    buffer_load_dword v30, v21, s[24:27], s45 offen
    s_lshl_b32 s45, s41, 13
    v_lshlrev_b32 v21, 7, v0
    buffer_load_dword v31, v21, s[28:31], s45 offen
    s_and_b32 s42, s15, 1
    s_lshl2_add_u32 s42, s42, s3
    v_lshlrev_b32 v22, 10, v0
L_h2:
    s_waitcnt vmcnt(0)
    s_barrier
    s_add_u32 m0, s56, 0
    s_nop 0
    buffer_load_dwordx4 v244, s[28:31], s66 offen offset:0 lds
    buffer_load_dwordx4 v245, s[28:31], s66 offen offset:1024 lds
    buffer_load_dwordx4 v246, s[28:31], s66 offen offset:2048 lds
    buffer_load_dwordx4 v247, s[28:31], s66 offen offset:3072 lds
    s_add_u32 s66, s66, 32768
    s_add_u32 m0, s56, 4096
    s_nop 0
    buffer_load_dwordx4 v244, s[28:31], s66 offen offset:0 lds
    buffer_load_dwordx4 v245, s[28:31], s66 offen offset:1024 lds
    buffer_load_dwordx4 v246, s[28:31], s66 offen offset:2048 lds
    buffer_load_dwordx4 v247, s[28:31], s66 offen offset:3072 lds
    s_add_u32 s66, s66, 229376
    s_add_u32 m0, s56, 32768
    s_nop 0
    buffer_load_dwordx4 v244, s[28:31], s66 offen offset:0 lds
    buffer_load_dwordx4 v245, s[28:31], s66 offen offset:1024 lds
    buffer_load_dwordx4 v246, s[28:31], s66 offen offset:2048 lds
    buffer_load_dwordx4 v247, s[28:31], s66 offen offset:3072 lds
    s_add_u32 s66, s66, 32768
    s_add_u32 m0, s56, 36864
    s_nop 0
    buffer_load_dwordx4 v244, s[28:31], s66 offen offset:0 lds
    buffer_load_dwordx4 v245, s[28:31], s66 offen offset:1024 lds
    buffer_load_dwordx4 v246, s[28:31], s66 offen offset:2048 lds
    buffer_load_dwordx4 v247, s[28:31], s66 offen offset:3072 lds
    s_add_u32 s66, s66, 229376
    s_waitcnt vmcnt(0)
L_phasec:
    s_lshl_b32 s39, s14, 1
    s_lshr_b32 s40, s15, 4
    s_add_u32 s39, s39, s40
    s_and_b32 s40, s15, 15
    v_and_b32 v8, 31, v0
    s_lshr_b32 s41, s3, 1
    v_lshl_add_u32 v8, s41, 5, v8
    v_cvt_f32_u32 v8, v8
    v_add_f32 v8, 0.5, v8
    v_mul_f32 v8, 0x3b4ccccd, v8
    v_lshrrev_b32 v9, 5, v0
    v_lshlrev_b32 v9, 4, v9
    v_cvt_f32_u32 v9, v9
    v_mul_f32 v9, v8, v9
    v_add_f32 v10, 0xbe800000, v9
    v_mul_f32 v208, 0x42000000, v8
    v_cos_f32 v208, v208
    v_fmamk_f32 v184, v8, 0x3f800000, v9
    v_fmamk_f32 v185, v8, 0x40400000, v9
    v_fmamk_f32 v186, v8, 0x40a00000, v9
    v_fmamk_f32 v187, v8, 0x40e00000, v9
    v_fmamk_f32 v188, v8, 0x41100000, v9
    v_fmamk_f32 v189, v8, 0x41300000, v9
    v_fmamk_f32 v190, v8, 0x41500000, v9
    v_fmamk_f32 v191, v8, 0x41700000, v9
    v_cos_f32 v184, v184
    v_cos_f32 v185, v185
    v_cos_f32 v186, v186
    v_cos_f32 v187, v187
    v_cos_f32 v188, v188
    v_cos_f32 v189, v189
    v_cos_f32 v190, v190
    v_cos_f32 v191, v191
    v_fmamk_f32 v192, v8, 0x42040000, v9
    v_fmamk_f32 v193, v8, 0x420c0000, v9
    v_fmamk_f32 v194, v8, 0x42140000, v9
    v_fmamk_f32 v195, v8, 0x421c0000, v9
    v_fmamk_f32 v196, v8, 0x42240000, v9
    v_fmamk_f32 v197, v8, 0x422c0000, v9
    v_fmamk_f32 v198, v8, 0x42340000, v9
    v_fmamk_f32 v199, v8, 0x423c0000, v9
    v_cos_f32 v192, v192
    v_cos_f32 v193, v193
    v_cos_f32 v194, v194
    v_cos_f32 v195, v195
    v_cos_f32 v196, v196
    v_cos_f32 v197, v197
    v_cos_f32 v198, v198
    v_cos_f32 v199, v199
    v_add_f32 v208, v208, v208
    v_cvt_pk_bf16_f32 v32, v184, v185
    v_cvt_pk_bf16_f32 v33, v186, v187
    v_cvt_pk_bf16_f32 v34, v188, v189
    v_cvt_pk_bf16_f32 v35, v190, v191
    v_cvt_pk_bf16_f32 v36, v192, v193
    v_cvt_pk_bf16_f32 v37, v194, v195
    v_cvt_pk_bf16_f32 v38, v196, v197
    v_cvt_pk_bf16_f32 v39, v198, v199
    v_pk_fma_f32 v[200:201], v[208:209], v[192:193], v[184:185] op_sel_hi:[0,1,1] neg_lo:[0,0,1] neg_hi:[0,0,1]
    v_pk_fma_f32 v[202:203], v[208:209], v[194:195], v[186:187] op_sel_hi:[0,1,1] neg_lo:[0,0,1] neg_hi:[0,0,1]
    v_pk_fma_f32 v[204:205], v[208:209], v[196:197], v[188:189] op_sel_hi:[0,1,1] neg_lo:[0,0,1] neg_hi:[0,0,1]
    v_pk_fma_f32 v[206:207], v[208:209], v[198:199], v[190:191] op_sel_hi:[0,1,1] neg_lo:[0,0,1] neg_hi:[0,0,1]
    v_cvt_pk_bf16_f32 v40, v200, v201
    v_cvt_pk_bf16_f32 v41, v202, v203
    v_cvt_pk_bf16_f32 v42, v204, v205
    v_cvt_pk_bf16_f32 v43, v206, v207
    v_pk_fma_f32 v[184:185], v[208:209], v[200:201], v[192:193] op_sel_hi:[0,1,1] neg_lo:[0,0,1] neg_hi:[0,0,1]
    v_pk_fma_f32 v[186:187], v[208:209], v[202:203], v[194:195] op_sel_hi:[0,1,1] neg_lo:[0,0,1] neg_hi:[0,0,1]
    v_pk_fma_f32 v[188:189], v[208:209], v[204:205], v[196:197] op_sel_hi:[0,1,1] neg_lo:[0,0,1] neg_hi:[0,0,1]
    v_pk_fma_f32 v[190:191], v[208:209], v[206:207], v[198:199] op_sel_hi:[0,1,1] neg_lo:[0,0,1] neg_hi:[0,0,1]
    v_cvt_pk_bf16_f32 v44, v184, v185
    v_cvt_pk_bf16_f32 v45, v186, v187
    v_cvt_pk_bf16_f32 v46, v188, v189
    v_cvt_pk_bf16_f32 v47, v190, v191
    v_pk_fma_f32 v[192:193], v[208:209], v[184:185], v[200:201] op_sel_hi:[0,1,1] neg_lo:[0,0,1] neg_hi:[0,0,1]
    v_pk_fma_f32 v[194:195], v[208:209], v[186:187], v[202:203] op_sel_hi:[0,1,1] neg_lo:[0,0,1] neg_hi:[0,0,1]
    v_pk_fma_f32 v[196:197], v[208:209], v[188:189], v[204:205] op_sel_hi:[0,1,1] neg_lo:[0,0,1] neg_hi:[0,0,1]
    v_pk_fma_f32 v[198:199], v[208:209], v[190:191], v[206:207] op_sel_hi:[0,1,1] neg_lo:[0,0,1] neg_hi:[0,0,1]
    v_cvt_pk_bf16_f32 v48, v192, v193
    v_cvt_pk_bf16_f32 v49, v194, v195
    v_cvt_pk_bf16_f32 v50, v196, v197
    v_cvt_pk_bf16_f32 v51, v198, v199
    v_mul_f32 v208, 0x42000000, v8
    v_cos_f32 v208, v208
    v_fmamk_f32 v184, v8, 0x3f800000, v10
    v_fmamk_f32 v185, v8, 0x40400000, v10
    v_fmamk_f32 v186, v8, 0x40a00000, v10
    v_fmamk_f32 v187, v8, 0x40e00000, v10
    v_fmamk_f32 v188, v8, 0x41100000, v10
    v_fmamk_f32 v189, v8, 0x41300000, v10
    v_fmamk_f32 v190, v8, 0x41500000, v10
    v_fmamk_f32 v191, v8, 0x41700000, v10
    v_cos_f32 v184, v184
    v_cos_f32 v185, v185
    v_cos_f32 v186, v186
    v_cos_f32 v187, v187
    v_cos_f32 v188, v188
    v_cos_f32 v189, v189
    v_cos_f32 v190, v190
    v_cos_f32 v191, v191
    v_fmamk_f32 v192, v8, 0x42040000, v10
    v_fmamk_f32 v193, v8, 0x420c0000, v10
    v_fmamk_f32 v194, v8, 0x42140000, v10
    v_fmamk_f32 v195, v8, 0x421c0000, v10
    v_fmamk_f32 v196, v8, 0x42240000, v10
    v_fmamk_f32 v197, v8, 0x422c0000, v10
    v_fmamk_f32 v198, v8, 0x42340000, v10
    v_fmamk_f32 v199, v8, 0x423c0000, v10
    v_cos_f32 v192, v192
    v_cos_f32 v193, v193
    v_cos_f32 v194, v194
    v_cos_f32 v195, v195
    v_cos_f32 v196, v196
    v_cos_f32 v197, v197
    v_cos_f32 v198, v198
    v_cos_f32 v199, v199
    v_add_f32 v208, v208, v208
    v_cvt_pk_bf16_f32 v52, v184, v185
    v_cvt_pk_bf16_f32 v53, v186, v187
    v_cvt_pk_bf16_f32 v54, v188, v189
    v_cvt_pk_bf16_f32 v55, v190, v191
    v_cvt_pk_bf16_f32 v56, v192, v193
    v_cvt_pk_bf16_f32 v57, v194, v195
    v_cvt_pk_bf16_f32 v58, v196, v197
    v_cvt_pk_bf16_f32 v59, v198, v199
    v_pk_fma_f32 v[200:201], v[208:209], v[192:193], v[184:185] op_sel_hi:[0,1,1] neg_lo:[0,0,1] neg_hi:[0,0,1]
    v_pk_fma_f32 v[202:203], v[208:209], v[194:195], v[186:187] op_sel_hi:[0,1,1] neg_lo:[0,0,1] neg_hi:[0,0,1]
    v_pk_fma_f32 v[204:205], v[208:209], v[196:197], v[188:189] op_sel_hi:[0,1,1] neg_lo:[0,0,1] neg_hi:[0,0,1]
    v_pk_fma_f32 v[206:207], v[208:209], v[198:199], v[190:191] op_sel_hi:[0,1,1] neg_lo:[0,0,1] neg_hi:[0,0,1]
    v_cvt_pk_bf16_f32 v60, v200, v201
    v_cvt_pk_bf16_f32 v61, v202, v203
    v_cvt_pk_bf16_f32 v62, v204, v205
    v_cvt_pk_bf16_f32 v63, v206, v207
    v_pk_fma_f32 v[184:185], v[208:209], v[200:201], v[192:193] op_sel_hi:[0,1,1] neg_lo:[0,0,1] neg_hi:[0,0,1]
    v_pk_fma_f32 v[186:187], v[208:209], v[202:203], v[194:195] op_sel_hi:[0,1,1] neg_lo:[0,0,1] neg_hi:[0,0,1]
    v_pk_fma_f32 v[188:189], v[208:209], v[204:205], v[196:197] op_sel_hi:[0,1,1] neg_lo:[0,0,1] neg_hi:[0,0,1]
    v_pk_fma_f32 v[190:191], v[208:209], v[206:207], v[198:199] op_sel_hi:[0,1,1] neg_lo:[0,0,1] neg_hi:[0,0,1]
    v_cvt_pk_bf16_f32 v64, v184, v185
    v_cvt_pk_bf16_f32 v65, v186, v187
    v_cvt_pk_bf16_f32 v66, v188, v189
    v_cvt_pk_bf16_f32 v67, v190, v191
    v_pk_fma_f32 v[192:193], v[208:209], v[184:185], v[200:201] op_sel_hi:[0,1,1] neg_lo:[0,0,1] neg_hi:[0,0,1]
    v_pk_fma_f32 v[194:195], v[208:209], v[186:187], v[202:203] op_sel_hi:[0,1,1] neg_lo:[0,0,1] neg_hi:[0,0,1]
    v_pk_fma_f32 v[196:197], v[208:209], v[188:189], v[204:205] op_sel_hi:[0,1,1] neg_lo:[0,0,1] neg_hi:[0,0,1]
    v_pk_fma_f32 v[198:199], v[208:209], v[190:191], v[206:207] op_sel_hi:[0,1,1] neg_lo:[0,0,1] neg_hi:[0,0,1]
    v_cvt_pk_bf16_f32 v68, v192, v193
    v_cvt_pk_bf16_f32 v69, v194, v195
    v_cvt_pk_bf16_f32 v70, v196, v197
    v_cvt_pk_bf16_f32 v71, v198, v199
    v_lshrrev_b32 v21, 1, v0
    v_lshlrev_b32 v21, 12, v21
    v_and_b32 v22, 1, v0
    v_lshl_add_u32 v21, v22, 8, v21
    s_lshr_b32 s41, s52, 3
    s_mul_i32 s41, s41, 5
    s_mul_i32 s42, s49, 10
    s_add_u32 s41, s41, s42
    s_add_u32 s41, s41, s48
    s_lshl_b32 s41, s41, 3
    s_and_b32 s42, s52, 7
    s_lshl_b32 s42, s42, 9
    s_add_u32 s41, s41, s42
    s_add_u32 s41, s41, 42205184
    s_lshl_b32 s43, s39, 4
    s_add_u32 s43, s43, s40
    s_lshl_b32 s42, s43, 8
    s_add_u32 s42, s42, 42205184
    s_and_b32 s44, s3, 1
    s_lshr_b32 s45, s3, 1
    s_lshl_b32 s46, s39, 5
    s_add_u32 s46, s46, s40
    s_lshl_b32 s47, s44, 4
    s_add_u32 s46, s46, s47
    s_mul_i32 s46, s46, 30
    s_add_u32 s46, s46, s45
    s_lshl_b32 s46, s46, 10
    s_add_u32 s46, s46, 4194304
    v_lshlrev_b32 v2, 4, v0
    v_add_u32 v3, 0x10000, v2
    s_lshl_b32 s47, s3, 10
    s_add_u32 s47, s47, 0x10000
    v_lshrrev_b32 v7, 4, v0
    v_lshlrev_b32 v7, 10, v7
    v_and_b32 v8, 15, v0
    v_lshl_add_u32 v8, s44, 4, v8
    v_lshl_add_u32 v10, v8, 4, v7
    v_add_u32 v10, 0x10000, v10
    v_xor_b32 v11, 0x1f0, v2
    v_lshrrev_b32 v7, 5, v0
    v_bfe_u32 v8, v0, 2, 2
    v_lshl_add_u32 v7, v7, 2, v8
    v_lshlrev_b32 v4, 7, v7
    v_bfe_u32 v7, v0, 4, 1
    v_and_b32 v8, 1, v0
    v_lshl_add_u32 v7, v7, 1, v8
    v_bfe_u32 v8, v0, 3, 1
    v_xor_b32 v8, s44, v8
    v_lshl_add_u32 v7, v8, 2, v7
    v_lshl_add_u32 v4, v7, 4, v4
    v_bfe_u32 v7, v0, 1, 1
    v_lshl_add_u32 v4, v7, 3, v4
    s_waitcnt vmcnt(16)
    s_barrier
    s_mov_b32 s51, 0
    s_mov_b32 s38, 0
    v_min_u32 v23, 29, v0
    v_lshlrev_b32 v23, 3, v23
    v_mov_b32 v20, 147456
    s_cmp_lg_u32 s3, 0
    s_cbranch_scc1 L_l0
    buffer_load_dwordx2 v[228:229], v23, s[24:27], s42 offen sc1
L_l0:
    ds_read_b64_tr_b16 a[0:1], v4 offset:0
    ds_read_b64_tr_b16 a[2:3], v4 offset:1024
    ds_read_b64_tr_b16 a[4:5], v4 offset:2048
    ds_read_b64_tr_b16 a[6:7], v4 offset:3072
    ds_read_b64_tr_b16 a[8:9], v4 offset:4096
    ds_read_b64_tr_b16 a[10:11], v4 offset:5120
    ds_read_b64_tr_b16 a[12:13], v4 offset:6144
    ds_read_b64_tr_b16 a[14:15], v4 offset:7168
    ds_read_b64_tr_b16 a[16:17], v4 offset:8192
    ds_read_b64_tr_b16 a[18:19], v4 offset:9216
    ds_read_b64_tr_b16 a[20:21], v4 offset:10240
    ds_read_b64_tr_b16 a[22:23], v4 offset:11264
    ds_read_b64_tr_b16 a[24:25], v4 offset:12288
    ds_read_b64_tr_b16 a[26:27], v4 offset:13312
    ds_read_b64_tr_b16 a[28:29], v4 offset:14336
    s_waitcnt lgkmcnt(13)
    ds_read_b64_tr_b16 a[30:31], v4 offset:15360
    ds_read_b64_tr_b16 a[32:33], v4 offset:16384
    s_waitcnt lgkmcnt(12)
    ds_read_b64_tr_b16 a[34:35], v4 offset:17408
    ds_read_b64_tr_b16 a[36:37], v4 offset:18432
    ds_read_b64_tr_b16 a[38:39], v4 offset:19456
    s_waitcnt lgkmcnt(11)
    ds_read_b64_tr_b16 a[40:41], v4 offset:20480
    ds_read_b64_tr_b16 a[42:43], v4 offset:21504
    ds_read_b64_tr_b16 a[44:45], v4 offset:22528
    ds_read_b64_tr_b16 a[46:47], v4 offset:23552
    s_waitcnt lgkmcnt(10)
    ds_read_b64_tr_b16 a[48:49], v4 offset:24576
    ds_read_b64_tr_b16 a[50:51], v4 offset:25600
    ds_read_b64_tr_b16 a[52:53], v4 offset:26624
    ds_read_b64_tr_b16 a[54:55], v4 offset:27648
    ds_read_b64_tr_b16 a[56:57], v4 offset:28672
    s_waitcnt lgkmcnt(11)
    ds_read_b64_tr_b16 a[58:59], v4 offset:29696
    ds_read_b64_tr_b16 a[60:61], v4 offset:30720
    ds_read_b64_tr_b16 a[62:63], v4 offset:31744
    ds_read_b64_tr_b16 a[64:65], v4 offset:32768
    s_waitcnt lgkmcnt(11)
    ds_read_b64_tr_b16 a[66:67], v4 offset:33792
    ds_read_b64_tr_b16 a[68:69], v4 offset:34816
    ds_read_b64_tr_b16 a[70:71], v4 offset:35840
    ds_read_b64_tr_b16 a[72:73], v4 offset:36864
    s_waitcnt lgkmcnt(11)
    ds_read_b64_tr_b16 a[74:75], v4 offset:37888
    ds_read_b64_tr_b16 a[76:77], v4 offset:38912
    ds_read_b64_tr_b16 a[78:79], v4 offset:39936
    ds_read_b64_tr_b16 a[80:81], v4 offset:40960
    s_waitcnt lgkmcnt(11)
    ds_read_b64_tr_b16 a[82:83], v4 offset:41984
    ds_read_b64_tr_b16 a[84:85], v4 offset:43008
    ds_read_b64_tr_b16 a[86:87], v4 offset:44032
    ds_read_b64_tr_b16 a[88:89], v4 offset:45056
    s_waitcnt lgkmcnt(11)
    ds_read_b64_tr_b16 a[90:91], v4 offset:46080
    ds_read_b64_tr_b16 a[92:93], v4 offset:47104
    ds_read_b64_tr_b16 a[94:95], v4 offset:48128
    ds_read_b64_tr_b16 a[96:97], v4 offset:49152
    s_waitcnt lgkmcnt(11)
    ds_read_b64_tr_b16 a[98:99], v4 offset:50176
    ds_read_b64_tr_b16 a[100:101], v4 offset:51200
    ds_read_b64_tr_b16 a[102:103], v4 offset:52224
    ds_read_b64_tr_b16 a[104:105], v4 offset:53248
    s_waitcnt lgkmcnt(11)
    ds_read_b64_tr_b16 a[106:107], v4 offset:54272
    ds_read_b64_tr_b16 a[108:109], v4 offset:55296
    ds_read_b64_tr_b16 a[110:111], v4 offset:56320
    ds_read_b64_tr_b16 a[112:113], v4 offset:57344
    s_waitcnt lgkmcnt(11)
    ds_read_b64_tr_b16 a[114:115], v4 offset:58368
    ds_read_b64_tr_b16 a[116:117], v4 offset:59392
    ds_read_b64_tr_b16 a[118:119], v4 offset:60416
    ds_read_b64_tr_b16 a[120:121], v4 offset:61440
    s_waitcnt lgkmcnt(11)
    ds_read_b64_tr_b16 a[122:123], v4 offset:62464
    ds_read_b64_tr_b16 a[124:125], v4 offset:63488
    ds_read_b64_tr_b16 a[126:127], v4 offset:64512
    s_waitcnt lgkmcnt(0)
    s_cmp_lg_u32 s3, 0
    s_cbranch_scc1 L_l1
    s_add_u32 s38, s38, 1
    s_waitcnt vmcnt(0)
    v_cmp_ne_u64 vcc, s[36:37], v[228:229]
    s_cmp_lt_u32 s38, 1048576
    s_nop 0
    s_cselect_b32 s51, vcc_lo, 0
L_l1:
    s_xor_b32 s50, s3, 1
    s_or_b32 s50, s50, s59
    s_waitcnt vmcnt(0)
    s_barrier
    s_cbranch_scc1 L_c0
    buffer_store_dwordx2 v[234:235], v232, s[24:27], s8 offen sc1
L_c0:
    s_mov_b32 s68, 0x3d13bb63
    s_mov_b32 s70, 0xbc93bb63
    v_and_b32 v22, 15, v0
    v_lshlrev_b32 v22, 2, v22
L_pollb2:
    s_and_b32 s50, s51, 1072693248
    s_cbranch_scc0 L_pollb2_out
    buffer_load_dwordx2 v[228:229], v23, s[24:27], s42 offen sc1
    s_add_u32 s38, s38, 1
    s_waitcnt vmcnt(0)
    v_cmp_ne_u64 vcc, s[36:37], v[228:229]
    s_cmp_lt_u32 s38, 1048576
    s_nop 0
    s_cselect_b32 s51, vcc_lo, 0
    s_branch L_pollb2
L_pollb2_out:
    s_barrier
    s_add_u32 m0, s47, 40960
    s_add_u32 s41, s46, 20480
    buffer_load_dwordx4 v2, s[24:27], s41 offen sc1 lds
    s_add_u32 m0, s47, 45056
    s_add_u32 s41, s46, 22528
    buffer_load_dwordx4 v2, s[24:27], s41 offen sc1 lds
    s_add_u32 m0, s47, 49152
    s_add_u32 s41, s46, 24576
    buffer_load_dwordx4 v2, s[24:27], s41 offen sc1 lds
    s_add_u32 m0, s47, 53248
    s_add_u32 s41, s46, 26624
    buffer_load_dwordx4 v2, s[24:27], s41 offen sc1 lds
    s_add_u32 m0, s47, 57344
    s_add_u32 s41, s46, 28672
    buffer_load_dwordx4 v2, s[24:27], s41 offen sc1 lds
L_pollb0:
    s_and_b32 s50, s51, 1023
    s_cbranch_scc0 L_pollb0_out
    buffer_load_dwordx2 v[228:229], v23, s[24:27], s42 offen sc1
    s_add_u32 s38, s38, 1
    s_waitcnt vmcnt(0)
    v_cmp_ne_u64 vcc, s[36:37], v[228:229]
    s_cmp_lt_u32 s38, 1048576
    s_nop 0
    s_cselect_b32 s51, vcc_lo, 0
    s_branch L_pollb0
L_pollb0_out:
    s_barrier
    s_add_u32 m0, s47, 0
    s_add_u32 s41, s46, 0
    buffer_load_dwordx4 v2, s[24:27], s41 offen sc1 lds
    s_add_u32 m0, s47, 4096
    s_add_u32 s41, s46, 2048
    buffer_load_dwordx4 v2, s[24:27], s41 offen sc1 lds
    s_add_u32 m0, s47, 8192
    s_add_u32 s41, s46, 4096
    buffer_load_dwordx4 v2, s[24:27], s41 offen sc1 lds
    s_add_u32 m0, s47, 12288
    s_add_u32 s41, s46, 6144
    buffer_load_dwordx4 v2, s[24:27], s41 offen sc1 lds
    s_add_u32 m0, s47, 16384
    s_add_u32 s41, s46, 8192
    buffer_load_dwordx4 v2, s[24:27], s41 offen sc1 lds
    s_waitcnt vmcnt(5)
    s_barrier
    ds_read_b128 v[72:75], v10 offset:40960
    ds_read_b128 v[76:79], v10 offset:41472
    ds_read_b128 v[80:83], v10 offset:45056
    ds_read_b128 v[84:87], v10 offset:45568
    ds_read_b128 v[88:91], v10 offset:49152
    ds_read_b128 v[92:95], v10 offset:49664
    ds_read_b128 v[96:99], v10 offset:53248
    ds_read_b128 v[100:103], v10 offset:53760
    ds_read_b128 v[104:107], v10 offset:57344
    ds_read_b128 v[108:111], v10 offset:57856
    s_waitcnt lgkmcnt(9)
    v_mfma_f32_32x32x16_bf16 v[120:135], v[72:75], v[32:35], 0
    s_waitcnt lgkmcnt(8)
    v_mfma_f32_32x32x16_bf16 v[136:151], v[76:79], v[52:55], 0
    s_waitcnt lgkmcnt(7)
    v_mfma_f32_32x32x16_bf16 v[120:135], v[80:83], v[36:39], v[120:135]
    s_waitcnt lgkmcnt(6)
    v_mfma_f32_32x32x16_bf16 v[136:151], v[84:87], v[56:59], v[136:151]
    s_waitcnt lgkmcnt(5)
    v_mfma_f32_32x32x16_bf16 v[120:135], v[88:91], v[40:43], v[120:135]
    s_waitcnt lgkmcnt(3)
    v_mfma_f32_32x32x16_bf16 v[136:151], v[92:95], v[60:63], v[136:151]
    v_mfma_f32_32x32x16_bf16 v[120:135], v[96:99], v[44:47], v[120:135]
    s_waitcnt lgkmcnt(0)
    v_mfma_f32_32x32x16_bf16 v[136:151], v[100:103], v[64:67], v[136:151]
    v_mfma_f32_32x32x16_bf16 v[120:135], v[104:107], v[48:51], v[120:135]
    v_mfma_f32_32x32x16_bf16 v[136:151], v[108:111], v[68:71], v[136:151]
L_pollb1:
    s_and_b32 s50, s51, 1047552
    s_cbranch_scc0 L_pollb1_out
    buffer_load_dwordx2 v[228:229], v23, s[24:27], s42 offen sc1
    s_add_u32 s38, s38, 1
    s_waitcnt vmcnt(0)
    v_cmp_ne_u64 vcc, s[36:37], v[228:229]
    s_cmp_lt_u32 s38, 1048576
    s_nop 0
    s_cselect_b32 s51, vcc_lo, 0
    s_branch L_pollb1
L_pollb1_out:
    s_barrier
    s_add_u32 m0, s47, 20480
    s_add_u32 s41, s46, 10240
    buffer_load_dwordx4 v2, s[24:27], s41 offen sc1 lds
    s_add_u32 m0, s47, 24576
    s_add_u32 s41, s46, 12288
    buffer_load_dwordx4 v2, s[24:27], s41 offen sc1 lds
    s_add_u32 m0, s47, 28672
    s_add_u32 s41, s46, 14336
    buffer_load_dwordx4 v2, s[24:27], s41 offen sc1 lds
    s_add_u32 m0, s47, 32768
    s_add_u32 s41, s46, 16384
    buffer_load_dwordx4 v2, s[24:27], s41 offen sc1 lds
    s_add_u32 m0, s47, 36864
    s_add_u32 s41, s46, 18432
    buffer_load_dwordx4 v2, s[24:27], s41 offen sc1 lds
    buffer_load_dword v255, v22, s[24:27], s100 offen sc1
    s_waitcnt vmcnt(6)
    s_barrier
    ds_read_b128 v[72:75], v10 offset:0
    ds_read_b128 v[76:79], v10 offset:512
    ds_read_b128 v[80:83], v10 offset:4096
    ds_read_b128 v[84:87], v10 offset:4608
    ds_read_b128 v[88:91], v10 offset:8192
    ds_read_b128 v[92:95], v10 offset:8704
    ds_read_b128 v[96:99], v10 offset:12288
    ds_read_b128 v[100:103], v10 offset:12800
    ds_read_b128 v[104:107], v10 offset:16384
    ds_read_b128 v[108:111], v10 offset:16896
    s_waitcnt lgkmcnt(9)
    v_mfma_f32_32x32x16_bf16 v[120:135], v[72:75], v[32:35], v[120:135]
    s_waitcnt lgkmcnt(8)
    v_mfma_f32_32x32x16_bf16 v[136:151], v[76:79], v[52:55], v[136:151]
    s_waitcnt lgkmcnt(7)
    v_mfma_f32_32x32x16_bf16 v[120:135], v[80:83], v[36:39], v[120:135]
    s_waitcnt lgkmcnt(6)
    v_mfma_f32_32x32x16_bf16 v[136:151], v[84:87], v[56:59], v[136:151]
    s_waitcnt lgkmcnt(5)
    v_mfma_f32_32x32x16_bf16 v[120:135], v[88:91], v[40:43], v[120:135]
    s_waitcnt lgkmcnt(3)
    v_mfma_f32_32x32x16_bf16 v[136:151], v[92:95], v[60:63], v[136:151]
    v_mfma_f32_32x32x16_bf16 v[120:135], v[96:99], v[44:47], v[120:135]
    s_waitcnt lgkmcnt(0)
    v_mfma_f32_32x32x16_bf16 v[136:151], v[100:103], v[64:67], v[136:151]
    v_mfma_f32_32x32x16_bf16 v[120:135], v[104:107], v[48:51], v[120:135]
    v_mfma_f32_32x32x16_bf16 v[136:151], v[108:111], v[68:71], v[136:151]
    s_waitcnt vmcnt(2)
    s_barrier
    ds_read_b128 v[72:75], v10 offset:20480
    ds_read_b128 v[76:79], v10 offset:20992
    ds_read_b128 v[80:83], v10 offset:24576
    ds_read_b128 v[84:87], v10 offset:25088
    ds_read_b128 v[88:91], v10 offset:28672
    ds_read_b128 v[92:95], v10 offset:29184
    ds_read_b128 v[96:99], v10 offset:32768
    ds_read_b128 v[100:103], v10 offset:33280
    s_waitcnt lgkmcnt(7)
    v_mfma_f32_32x32x16_bf16 v[120:135], v[72:75], v[32:35], v[120:135]
    s_waitcnt lgkmcnt(6)
    v_mfma_f32_32x32x16_bf16 v[136:151], v[76:79], v[52:55], v[136:151]
    s_waitcnt lgkmcnt(5)
    v_mfma_f32_32x32x16_bf16 v[120:135], v[80:83], v[36:39], v[120:135]
    s_waitcnt lgkmcnt(4)
    v_mfma_f32_32x32x16_bf16 v[136:151], v[84:87], v[56:59], v[136:151]
    s_waitcnt lgkmcnt(3)
    v_mfma_f32_32x32x16_bf16 v[120:135], v[88:91], v[40:43], v[120:135]
    s_waitcnt lgkmcnt(2)
    v_mfma_f32_32x32x16_bf16 v[136:151], v[92:95], v[60:63], v[136:151]
    s_waitcnt lgkmcnt(1)
    v_mfma_f32_32x32x16_bf16 v[120:135], v[96:99], v[44:47], v[120:135]
    s_waitcnt lgkmcnt(0)
    v_mfma_f32_32x32x16_bf16 v[136:151], v[100:103], v[64:67], v[136:151]
    s_waitcnt vmcnt(0)
    s_barrier
    ds_read_b128 v[72:75], v10 offset:36864
    ds_read_b128 v[76:79], v10 offset:37376
    s_waitcnt lgkmcnt(1)
    v_mfma_f32_32x32x16_bf16 v[120:135], v[72:75], v[48:51], v[120:135]
    s_waitcnt lgkmcnt(0)
    v_mfma_f32_32x32x16_bf16 v[136:151], v[76:79], v[68:71], v[136:151]
    s_lshl_b32 s50, s39, 5
    s_add_u32 s50, s50, s40
    s_mul_i32 s50, s50, 30
    s_add_u32 s50, s50, s44
    s_lshl_b32 s50, s50, 10
    s_lshl_b32 s41, s45, 11
    s_sub_u32 s5, s50, s41
    s_add_u32 s5, s5, 4206592
    s_add_u32 s50, s50, s41
    s_add_u32 s50, s50, 4208640
    v_pk_mul_f32 v[120:121], v[120:121], s[68:69] op_sel_hi:[1,0]
    v_pk_mul_f32 v[122:123], v[122:123], s[68:69] op_sel_hi:[1,0]
    v_pk_mul_f32 v[124:125], v[124:125], s[68:69] op_sel_hi:[1,0]
    v_pk_mul_f32 v[126:127], v[126:127], s[68:69] op_sel_hi:[1,0]
    v_pk_mul_f32 v[128:129], v[128:129], s[70:71] op_sel_hi:[1,0]
    v_pk_mul_f32 v[130:131], v[130:131], s[70:71] op_sel_hi:[1,0]
    v_pk_mul_f32 v[132:133], v[132:133], s[70:71] op_sel_hi:[1,0]
    v_pk_mul_f32 v[134:135], v[134:135], s[70:71] op_sel_hi:[1,0]
    v_pk_fma_f32 v[72:73], v[136:137], s[68:69], v[120:121] op_sel_hi:[1,0,1] neg_lo:[1,0,0] neg_hi:[1,0,0]
    v_pk_fma_f32 v[80:81], v[136:137], s[68:69], v[120:121] op_sel_hi:[1,0,1]
    v_pk_fma_f32 v[74:75], v[138:139], s[68:69], v[122:123] op_sel_hi:[1,0,1] neg_lo:[1,0,0] neg_hi:[1,0,0]
    v_pk_fma_f32 v[82:83], v[138:139], s[68:69], v[122:123] op_sel_hi:[1,0,1]
    v_pk_fma_f32 v[76:77], v[140:141], s[68:69], v[124:125] op_sel_hi:[1,0,1] neg_lo:[1,0,0] neg_hi:[1,0,0]
    v_pk_fma_f32 v[84:85], v[140:141], s[68:69], v[124:125] op_sel_hi:[1,0,1]
    v_pk_fma_f32 v[78:79], v[142:143], s[68:69], v[126:127] op_sel_hi:[1,0,1] neg_lo:[1,0,0] neg_hi:[1,0,0]
    v_pk_fma_f32 v[86:87], v[142:143], s[68:69], v[126:127] op_sel_hi:[1,0,1]
    v_pk_fma_f32 v[88:89], v[144:145], s[70:71], v[128:129] op_sel_hi:[1,0,1] neg_lo:[1,0,0] neg_hi:[1,0,0]
    v_pk_fma_f32 v[96:97], v[144:145], s[70:71], v[128:129] op_sel_hi:[1,0,1]
    v_pk_fma_f32 v[90:91], v[146:147], s[70:71], v[130:131] op_sel_hi:[1,0,1] neg_lo:[1,0,0] neg_hi:[1,0,0]
    v_pk_fma_f32 v[98:99], v[146:147], s[70:71], v[130:131] op_sel_hi:[1,0,1]
    v_pk_fma_f32 v[92:93], v[148:149], s[70:71], v[132:133] op_sel_hi:[1,0,1] neg_lo:[1,0,0] neg_hi:[1,0,0]
    v_pk_fma_f32 v[100:101], v[148:149], s[70:71], v[132:133] op_sel_hi:[1,0,1]
    v_pk_fma_f32 v[94:95], v[150:151], s[70:71], v[134:135] op_sel_hi:[1,0,1] neg_lo:[1,0,0] neg_hi:[1,0,0]
    v_pk_fma_f32 v[102:103], v[150:151], s[70:71], v[134:135] op_sel_hi:[1,0,1]
    v_exp_f32 v72, v72
    v_exp_f32 v73, v73
    v_exp_f32 v74, v74
    v_exp_f32 v75, v75
    v_exp_f32 v76, v76
    v_exp_f32 v77, v77
    v_exp_f32 v78, v78
    v_exp_f32 v79, v79
    v_exp_f32 v80, v80
    v_exp_f32 v81, v81
    v_exp_f32 v82, v82
    v_exp_f32 v83, v83
    v_exp_f32 v84, v84
    v_exp_f32 v85, v85
    v_exp_f32 v86, v86
    v_exp_f32 v87, v87
    v_pk_add_f32 v[72:73], v[72:73], 1.0 op_sel_hi:[1,0]
    v_pk_add_f32 v[74:75], v[74:75], 1.0 op_sel_hi:[1,0]
    v_pk_add_f32 v[76:77], v[76:77], 1.0 op_sel_hi:[1,0]
    v_pk_add_f32 v[78:79], v[78:79], 1.0 op_sel_hi:[1,0]
    v_pk_add_f32 v[80:81], v[80:81], 1.0 op_sel_hi:[1,0]
    v_pk_add_f32 v[82:83], v[82:83], 1.0 op_sel_hi:[1,0]
    v_pk_add_f32 v[84:85], v[84:85], 1.0 op_sel_hi:[1,0]
    v_pk_add_f32 v[86:87], v[86:87], 1.0 op_sel_hi:[1,0]
    v_rcp_f32 v72, v72
    v_rcp_f32 v73, v73
    v_rcp_f32 v74, v74
    v_rcp_f32 v75, v75
    v_rcp_f32 v76, v76
    v_rcp_f32 v77, v77
    v_rcp_f32 v78, v78
    v_rcp_f32 v79, v79
    v_rcp_f32 v80, v80
    v_rcp_f32 v81, v81
    v_rcp_f32 v82, v82
    v_rcp_f32 v83, v83
    v_rcp_f32 v84, v84
    v_rcp_f32 v85, v85
    v_rcp_f32 v86, v86
    v_rcp_f32 v87, v87
    v_pk_fma_f32 v[72:73], v[72:73], -2.0, 1.0 op_sel_hi:[1,0,0]
    v_pk_fma_f32 v[74:75], v[74:75], -2.0, 1.0 op_sel_hi:[1,0,0]
    v_pk_fma_f32 v[76:77], v[76:77], -2.0, 1.0 op_sel_hi:[1,0,0]
    v_pk_fma_f32 v[78:79], v[78:79], -2.0, 1.0 op_sel_hi:[1,0,0]
    v_pk_fma_f32 v[80:81], v[80:81], -2.0, 1.0 op_sel_hi:[1,0,0]
    v_pk_fma_f32 v[82:83], v[82:83], -2.0, 1.0 op_sel_hi:[1,0,0]
    v_pk_fma_f32 v[84:85], v[84:85], -2.0, 1.0 op_sel_hi:[1,0,0]
    v_pk_fma_f32 v[86:87], v[86:87], -2.0, 1.0 op_sel_hi:[1,0,0]
    v_exp_f32 v88, v88
    v_exp_f32 v89, v89
    v_exp_f32 v90, v90
    v_exp_f32 v91, v91
    v_exp_f32 v92, v92
    v_exp_f32 v93, v93
    v_exp_f32 v94, v94
    v_exp_f32 v95, v95
    v_exp_f32 v96, v96
    v_exp_f32 v97, v97
    v_exp_f32 v98, v98
    v_exp_f32 v99, v99
    v_exp_f32 v100, v100
    v_exp_f32 v101, v101
    v_exp_f32 v102, v102
    v_exp_f32 v103, v103
    v_pk_add_f32 v[88:89], v[88:89], 1.0 op_sel_hi:[1,0]
    v_pk_add_f32 v[90:91], v[90:91], 1.0 op_sel_hi:[1,0]
    v_pk_add_f32 v[92:93], v[92:93], 1.0 op_sel_hi:[1,0]
    v_pk_add_f32 v[94:95], v[94:95], 1.0 op_sel_hi:[1,0]
    v_pk_add_f32 v[96:97], v[96:97], 1.0 op_sel_hi:[1,0]
    v_pk_add_f32 v[98:99], v[98:99], 1.0 op_sel_hi:[1,0]
    v_pk_add_f32 v[100:101], v[100:101], 1.0 op_sel_hi:[1,0]
    v_pk_add_f32 v[102:103], v[102:103], 1.0 op_sel_hi:[1,0]
    v_rcp_f32 v88, v88
    v_rcp_f32 v89, v89
    v_rcp_f32 v90, v90
    v_rcp_f32 v91, v91
    v_rcp_f32 v92, v92
    v_rcp_f32 v93, v93
    v_rcp_f32 v94, v94
    v_rcp_f32 v95, v95
    v_rcp_f32 v96, v96
    v_rcp_f32 v97, v97
    v_rcp_f32 v98, v98
    v_rcp_f32 v99, v99
    v_rcp_f32 v100, v100
    v_rcp_f32 v101, v101
    v_rcp_f32 v102, v102
    v_rcp_f32 v103, v103
    v_pk_mul_f32 v[72:73], v[72:73], v[88:89]
    v_pk_mul_f32 v[74:75], v[74:75], v[90:91]
    v_pk_mul_f32 v[76:77], v[76:77], v[92:93]
    v_pk_mul_f32 v[78:79], v[78:79], v[94:95]
    v_pk_mul_f32 v[80:81], v[80:81], v[96:97]
    v_pk_mul_f32 v[82:83], v[82:83], v[98:99]
    v_pk_mul_f32 v[84:85], v[84:85], v[100:101]
    v_pk_mul_f32 v[86:87], v[86:87], v[102:103]
    v_cmp_ne_u32 vcc, v254, v255
    v_cvt_pk_bf16_f32 v12, v72, v73
    v_cvt_pk_bf16_f32 v13, v74, v75
    v_cvt_pk_bf16_f32 v14, v76, v77
    v_cvt_pk_bf16_f32 v15, v78, v79
    v_cvt_pk_bf16_f32 v16, v80, v81
    v_cvt_pk_bf16_f32 v17, v82, v83
    v_cvt_pk_bf16_f32 v18, v84, v85
    v_cvt_pk_bf16_f32 v19, v86, v87
    s_cbranch_vccnz L_zfar
    buffer_store_dwordx4 v[12:15], v2, s[24:27], s50 offen
    buffer_store_dwordx4 v[16:19], v11, s[24:27], s5 offen
    s_branch L_zdone
L_zfar:
    buffer_store_dwordx4 v[12:15], v2, s[24:27], s50 offen sc1
    buffer_store_dwordx4 v[16:19], v11, s[24:27], s5 offen sc1
L_zdone:
    s_mov_b32 s101, vcc_lo
    v_lshlrev_b32 v21, 7, v0
    s_lshl_b32 s41, s39, 11
    s_lshl_b32 s42, s40, 3
    s_add_u32 s41, s41, s42
    s_add_u32 s41, s41, 42074112
    s_lshl_b32 s42, s43, 7
    s_add_u32 s42, s42, 42074112
    s_lshl_b32 s46, s39, 1
    s_lshr_b32 s47, s40, 3
    s_add_u32 s46, s46, s47
    s_and_b32 s47, s40, 7
    s_mov_b32 s60, s50
    s_lshl_b32 s50, s39, 5
    s_add_u32 s50, s50, s44
    s_mul_i32 s50, s50, 30720
    s_and_b32 s53, s46, 1
    s_lshl_b32 s53, s53, 1
    s_add_u32 s53, s53, s45
    s_lshl_b32 s53, s53, 11
    s_add_u32 s50, s50, s53
    s_add_u32 s50, s50, 4204544
    s_lshl_b32 s53, s45, 15
    v_add_u32 v5, s53, v3
    s_lshl_b32 s51, s44, 11
    s_add_u32 s51, s51, s53
    s_add_u32 s51, s51, 0x10000
    s_lshr_b32 s54, s46, 4
    s_bfe_u32 s55, s46, 0x10003
    s_and_b32 s56, s46, 7
    s_lshl_b32 s56, s56, 6
    s_lshl_b32 s57, s45, 5
    s_add_u32 s56, s56, s57
    s_mul_i32 s54, s54, 1000
    s_add_u32 s54, s54, s55
    s_lshl_b32 s54, s54, 10
    s_lshl_b32 s55, s47, 7
    s_add_u32 s54, s54, s55
    s_lshl_b32 s55, s44, 6
    s_add_u32 s54, s54, s55
    v_and_b32 v7, 31, v0
    v_add_u32 v7, s56, v7
    v_lshrrev_b32 v8, 5, v0
    v_lshlrev_b32 v8, 4, v8
    v_add_u32 v8, s54, v8
    v_lshl_add_u32 v6, v7, 11, v8
    v_mov_b32 v9, 2146435072
    s_movk_i32 s55, 500
    v_cmp_gt_u32 vcc, s55, v7
    s_nop 1
    v_cndmask_b32 v6, v9, v6, vcc
    s_waitcnt vmcnt(0)
    s_barrier
    s_cmp_lg_u32 s3, 0
    s_cbranch_scc1 L_d1
    s_cmp_lg_u32 s101, 0
    s_cbranch_scc1 L_pfar
    v_mov_b32 v222, s36
    v_mov_b32 v223, s37
    s_mov_b32 exec_lo, 65535
    s_mov_b32 exec_hi, 0
    buffer_store_dwordx2 v[222:223], v21, s[24:27], s41 offen
    s_mov_b64 exec, -1
    s_branch L_pdone
L_pfar:
    v_mov_b32 v222, s36
    v_mov_b32 v223, s37
    s_mov_b32 exec_lo, 65535
    s_mov_b32 exec_hi, 0
    buffer_store_dwordx2 v[222:223], v21, s[24:27], s41 offen sc1
    s_mov_b64 exec, -1
L_pdone:
    v_lshlrev_b32 v232, 3, v0
    s_mov_b32 s38, 0
    s_mov_b32 exec_lo, 65535
    s_mov_b32 exec_hi, 0
L_pollc:
    buffer_load_dwordx2 v[228:229], v232, s[24:27], s42 offen sc1
    s_add_u32 s38, s38, 1
    s_waitcnt vmcnt(0)
    v_cmp_ne_u64 vcc, s[36:37], v[228:229]
    s_cmp_ge_u32 s38, 1048576
    s_cbranch_scc1 L_pollc_out
    s_cbranch_vccnz L_pollc
L_pollc_out:
    s_mov_b64 exec, -1
L_d1:
    s_barrier
    s_add_u32 m0, s51, 0
    s_add_u32 s41, s50, 0
    buffer_load_dwordx4 v2, s[24:27], s41 offen offset:0 sc1 lds
    buffer_load_dwordx4 v2, s[24:27], s41 offen offset:1024 sc1 lds
    s_add_u32 m0, s51, 4096
    s_add_u32 s41, s50, 61440
    buffer_load_dwordx4 v2, s[24:27], s41 offen offset:0 sc1 lds
    buffer_load_dwordx4 v2, s[24:27], s41 offen offset:1024 sc1 lds
    s_add_u32 m0, s51, 8192
    s_add_u32 s41, s50, 122880
    buffer_load_dwordx4 v2, s[24:27], s41 offen offset:0 sc1 lds
    buffer_load_dwordx4 v2, s[24:27], s41 offen offset:1024 sc1 lds
    s_add_u32 m0, s51, 12288
    s_add_u32 s41, s50, 184320
    buffer_load_dwordx4 v2, s[24:27], s41 offen offset:0 sc1 lds
    buffer_load_dwordx4 v2, s[24:27], s41 offen offset:1024 sc1 lds
    s_waitcnt vmcnt(6)
    s_barrier
    s_add_u32 m0, s51, 16384
    s_add_u32 s41, s50, 245760
    ds_read_b128 v[32:35], v5 offset:0
    ds_read_b128 v[36:39], v5 offset:1024
    buffer_load_dwordx4 v2, s[24:27], s41 offen offset:0 sc1 lds
    ds_read_b128 v[40:43], v5 offset:2048
    ds_read_b128 v[44:47], v5 offset:3072
    buffer_load_dwordx4 v2, s[24:27], s41 offen offset:1024 sc1 lds
    s_waitcnt vmcnt(6)
    s_barrier
    s_add_u32 m0, s51, 20480
    s_add_u32 s41, s50, 307200
    s_waitcnt lgkmcnt(3)
    v_mfma_f32_32x32x16_bf16 v[96:111], a[0:3], v[32:35], 0
    ds_read_b128 v[48:51], v5 offset:4096
    ds_read_b128 v[52:55], v5 offset:5120
    buffer_load_dwordx4 v2, s[24:27], s41 offen offset:0 sc1 lds
    s_waitcnt lgkmcnt(4)
    v_mfma_f32_32x32x16_bf16 v[96:111], a[4:7], v[36:39], v[96:111]
    ds_read_b128 v[56:59], v5 offset:6144
    ds_read_b128 v[60:63], v5 offset:7168
    s_waitcnt lgkmcnt(4)
    v_mfma_f32_32x32x16_bf16 v[96:111], a[8:11], v[40:43], v[96:111]
    buffer_load_dwordx4 v2, s[24:27], s41 offen offset:1024 sc1 lds
    v_mfma_f32_32x32x16_bf16 v[96:111], a[12:15], v[44:47], v[96:111]
    s_waitcnt vmcnt(6)
    s_barrier
    s_add_u32 m0, s51, 24576
    s_add_u32 s41, s50, 368640
    s_waitcnt lgkmcnt(2)
    v_mfma_f32_32x32x16_bf16 v[96:111], a[16:19], v[48:51], v[96:111]
    ds_read_b128 v[32:35], v5 offset:8192
    ds_read_b128 v[36:39], v5 offset:9216
    buffer_load_dwordx4 v2, s[24:27], s41 offen offset:0 sc1 lds
    v_mfma_f32_32x32x16_bf16 v[96:111], a[20:23], v[52:55], v[96:111]
    ds_read_b128 v[40:43], v5 offset:10240
    ds_read_b128 v[44:47], v5 offset:11264
    s_waitcnt lgkmcnt(4)
    v_mfma_f32_32x32x16_bf16 v[96:111], a[24:27], v[56:59], v[96:111]
    buffer_load_dwordx4 v2, s[24:27], s41 offen offset:1024 sc1 lds
    v_mfma_f32_32x32x16_bf16 v[96:111], a[28:31], v[60:63], v[96:111]
    s_waitcnt vmcnt(6)
    s_barrier
    s_add_u32 m0, s51, 28672
    s_add_u32 s41, s50, 430080
    s_waitcnt lgkmcnt(3)
    v_mfma_f32_32x32x16_bf16 v[96:111], a[32:35], v[32:35], v[96:111]
    ds_read_b128 v[48:51], v5 offset:12288
    ds_read_b128 v[52:55], v5 offset:13312
    buffer_load_dwordx4 v2, s[24:27], s41 offen offset:0 sc1 lds
    s_waitcnt lgkmcnt(2)
    v_mfma_f32_32x32x16_bf16 v[96:111], a[36:39], v[36:39], v[96:111]
    ds_read_b128 v[56:59], v5 offset:14336
    ds_read_b128 v[60:63], v5 offset:15360
    v_mfma_f32_32x32x16_bf16 v[96:111], a[40:43], v[40:43], v[96:111]
    buffer_load_dwordx4 v2, s[24:27], s41 offen offset:1024 sc1 lds
    v_mfma_f32_32x32x16_bf16 v[96:111], a[44:47], v[44:47], v[96:111]
    s_waitcnt vmcnt(6)
    s_barrier
    s_waitcnt lgkmcnt(3)
    v_mfma_f32_32x32x16_bf16 v[96:111], a[48:51], v[48:51], v[96:111]
    ds_read_b128 v[32:35], v5 offset:16384
    ds_read_b128 v[36:39], v5 offset:17408
    s_waitcnt lgkmcnt(4)
    v_mfma_f32_32x32x16_bf16 v[96:111], a[52:55], v[52:55], v[96:111]
    ds_read_b128 v[40:43], v5 offset:18432
    ds_read_b128 v[44:47], v5 offset:19456
    s_waitcnt lgkmcnt(4)
    v_mfma_f32_32x32x16_bf16 v[96:111], a[56:59], v[56:59], v[96:111]
    v_mfma_f32_32x32x16_bf16 v[96:111], a[60:63], v[60:63], v[96:111]
    s_waitcnt vmcnt(4)
    s_barrier
    s_waitcnt lgkmcnt(3)
    v_mfma_f32_32x32x16_bf16 v[96:111], a[64:67], v[32:35], v[96:111]
    ds_read_b128 v[48:51], v5 offset:20480
    ds_read_b128 v[52:55], v5 offset:21504
    s_waitcnt lgkmcnt(4)
    v_mfma_f32_32x32x16_bf16 v[96:111], a[68:71], v[36:39], v[96:111]
    ds_read_b128 v[56:59], v5 offset:22528
    ds_read_b128 v[60:63], v5 offset:23552
    s_waitcnt lgkmcnt(4)
    v_mfma_f32_32x32x16_bf16 v[96:111], a[72:75], v[40:43], v[96:111]
    v_mfma_f32_32x32x16_bf16 v[96:111], a[76:79], v[44:47], v[96:111]
    s_waitcnt vmcnt(2)
    s_barrier
    s_waitcnt lgkmcnt(3)
    v_mfma_f32_32x32x16_bf16 v[96:111], a[80:83], v[48:51], v[96:111]
    ds_read_b128 v[32:35], v5 offset:24576
    ds_read_b128 v[36:39], v5 offset:25600
    s_waitcnt lgkmcnt(4)
    v_mfma_f32_32x32x16_bf16 v[96:111], a[84:87], v[52:55], v[96:111]
    ds_read_b128 v[40:43], v5 offset:26624
    ds_read_b128 v[44:47], v5 offset:27648
    s_waitcnt lgkmcnt(4)
    v_mfma_f32_32x32x16_bf16 v[96:111], a[88:91], v[56:59], v[96:111]
    v_mfma_f32_32x32x16_bf16 v[96:111], a[92:95], v[60:63], v[96:111]
    s_waitcnt vmcnt(0)
    s_barrier
    s_waitcnt lgkmcnt(3)
    v_mfma_f32_32x32x16_bf16 v[96:111], a[96:99], v[32:35], v[96:111]
    ds_read_b128 v[48:51], v5 offset:28672
    ds_read_b128 v[52:55], v5 offset:29696
    s_waitcnt lgkmcnt(4)
    v_mfma_f32_32x32x16_bf16 v[96:111], a[100:103], v[36:39], v[96:111]
    ds_read_b128 v[56:59], v5 offset:30720
    ds_read_b128 v[60:63], v5 offset:31744
    s_waitcnt lgkmcnt(4)
    v_mfma_f32_32x32x16_bf16 v[96:111], a[104:107], v[40:43], v[96:111]
    v_mfma_f32_32x32x16_bf16 v[96:111], a[108:111], v[44:47], v[96:111]
    s_waitcnt lgkmcnt(3)
    v_mfma_f32_32x32x16_bf16 v[96:111], a[112:115], v[48:51], v[96:111]
    s_waitcnt lgkmcnt(2)
    v_mfma_f32_32x32x16_bf16 v[96:111], a[116:119], v[52:55], v[96:111]
    s_waitcnt lgkmcnt(1)
    v_mfma_f32_32x32x16_bf16 v[96:111], a[120:123], v[56:59], v[96:111]
    s_waitcnt lgkmcnt(0)
    v_mfma_f32_32x32x16_bf16 v[96:111], a[124:127], v[60:63], v[96:111]
    s_nop 11
    v_cvt_pk_bf16_f32 v64, v96, v97
    v_cvt_pk_bf16_f32 v65, v98, v99
    v_cvt_pk_bf16_f32 v66, v100, v101
    v_cvt_pk_bf16_f32 v67, v102, v103
    buffer_store_dwordx4 v[64:67], v6, s[32:35], 0 offen offset:0
    v_cvt_pk_bf16_f32 v68, v104, v105
    v_cvt_pk_bf16_f32 v69, v106, v107
    v_cvt_pk_bf16_f32 v70, v108, v109
    v_cvt_pk_bf16_f32 v71, v110, v111
    buffer_store_dwordx4 v[68:71], v6, s[32:35], 0 offen offset:32
    s_or_b32 s41, s2, s3
    s_cmp_lg_u32 s41, 0
    s_cbranch_scc1 L_fin
    v_mov_b32 v21, 0
    s_mov_b32 s41, 42139648
    v_mov_b32 v222, s36
    v_mov_b32 v223, s37
    s_mov_b32 exec_lo, 1
    s_mov_b32 exec_hi, 0
    buffer_store_dwordx2 v[222:223], v21, s[24:27], s41 offen sc1
    s_mov_b64 exec, -1
L_fin:
L_end:
    s_endpgm
.section .rodata,"a"
.p2align 6
.amdhsa_kernel standalone__autoregressive_conv_wavenet__speech_kernel
  .amdhsa_next_free_vgpr 448
  .amdhsa_next_free_sgpr 102
  .amdhsa_accum_offset 256
  .amdhsa_group_segment_fixed_size 0
  .amdhsa_kernarg_size 48
  .amdhsa_user_sgpr_count 2
  .amdhsa_user_sgpr_kernarg_segment_ptr 1
  .amdhsa_system_sgpr_workgroup_id_x 1
  .amdhsa_float_denorm_mode_32 3
.end_amdhsa_kernel
```
